```python
import torch

def _softmax(x, axis=-1):
    return torch.softmax(x, dim=axis)
def _gelu(x):
    return torch.nn.functional.gelu(x, approximate="tanh")
def _silu(x):
    return torch.nn.functional.silu(x)
def _sigmoid(x):
    return torch.sigmoid(x)
def _layernorm(x, axis=-1, eps=1e-5):
    m = x.mean(dim=axis, keepdim=True)
    v = x.var(dim=axis, keepdim=True, unbiased=False)
    return (x - m) / torch.sqrt(v + eps)
def _scatter_add(tgt, idx, src, axis=0):
    return tgt.clone().index_add_(axis, idx, src)
def _segment_sum(src, seg, n):
    out = torch.zeros((n,) + src.shape[1:], dtype=src.dtype)
    return out.index_add_(0, seg, src)
def _pad(x, pw):
    flat = tuple(v for pair in reversed(pw) for v in pair)
    return torch.nn.functional.pad(x, flat)

kernel_name = 'sequential_preLN__sliding_block__moe_arch_mod__prompt'

def setup_inputs():

    _w = (lambda a: (lambda t: t.to(torch.bfloat16) if t.is_floating_point() else t)(torch.as_tensor(a)))
    def _A_setup():
        B, S, D = 1, 2048, 512
        return {
            "x": _w((lambda *s: torch.randn(*s, dtype=torch.bfloat16) * 0.05)(B, S, D)),
            "wqkv": _w((lambda *s: torch.randn(*s, dtype=torch.bfloat16) * 0.05)(D, 3 * D)),
            "wo": _w((lambda *s: torch.randn(*s, dtype=torch.bfloat16) * 0.05)(D, D)),
        }
    _A_in = _A_setup()

    def _B_setup():
        B, S, D, F, C = 1, 2048, 512, 1792, 1
        return {
            "x": _w((lambda *s: torch.randn(*s, dtype=torch.bfloat16) * 0.05)(B, S, D)),
            "w_r": _w((lambda *s: torch.randn(*s, dtype=torch.bfloat16) * 0.05)(D)),
            "w_gate": _w((lambda *s: torch.randn(*s, dtype=torch.bfloat16) * 0.05)(D, F)),
            "w_up": _w((lambda *s: torch.randn(*s, dtype=torch.bfloat16) * 0.05)(D, F)),
            "w_down": _w((lambda *s: torch.randn(*s, dtype=torch.bfloat16) * 0.05)(F, D)),
        }
    _B_in = _B_setup()

    return {
        "A_x": _A_in["x"],
        "A_wqkv": _A_in["wqkv"],
        "A_wo": _A_in["wo"],
        "B_x": _B_in["x"],
        "B_w_r": _B_in["w_r"],
        "B_w_gate": _B_in["w_gate"],
        "B_w_up": _B_in["w_up"],
        "B_w_down": _B_in["w_down"],
    }

def reference(A_x, A_wqkv, A_wo, B_x, B_w_r, B_w_gate, B_w_up, B_w_down):
    def _A_ref(x, wqkv, wo):
        B, S, D = x.shape
        H = 32; Dh = D // H; W = 256
        qkv = (lambda x, *d: x.permute(*d))((x @ wqkv).reshape(B, S, 3, H, Dh), 2, 0, 3, 1, 4)
        q, k, v = qkv[0], qkv[1], qkv[2]
        scores = torch.einsum("bhqd,bhkd->bhqk", q, k) * (Dh ** -0.5)
        idx = torch.arange(S)
        mask = (idx[:, None] - idx[None, :] >= 0) & (idx[:, None] - idx[None, :] < W)
        scores = torch.where(mask[None, None], scores, -1e9)
        p = _softmax(scores, axis=-1)
        o = torch.einsum("bhqk,bhkd->bhqd", p, v)
        return (lambda x, *d: x.permute(*d))(o, 0, 2, 1, 3).reshape(B, S, D) @ wo

    def _B_ref(x, w_r, w_gate, w_up, w_down):
        B, S, D = x.shape
        C = 1
        r = x @ w_r
        idx = torch.argsort(-r, axis=-1)[:, :C]
        idx_e = (lambda x, n, axis: torch.repeat_interleave(x, n, dim=axis))(idx.reshape(B, C, 1), D, axis=2)
        x_sel = (lambda x, i, axis: torch.take_along_dim(x, i, dim=axis))(x, idx_e, axis=1)
        g = _silu(x_sel @ w_gate)
        u = x_sel @ w_up
        y = (g * u) @ w_down
        r_sel = _sigmoid((lambda x, i, axis: torch.take_along_dim(x, i, dim=axis))(r, idx, axis=1))
        y = y * r_sel.reshape(B, C, 1)
        b_off = (torch.arange(B) * S).reshape(B, 1)
        flat_idx = (idx + b_off).reshape(B * C)
        zero = (x * 0.0).reshape(B * S, D)
        upd = _scatter_add(zero, flat_idx, y.reshape(B * C, D), axis=0)
        return x + upd.reshape(B, S, D)

    x = A_x
    h = x + _A_ref(_layernorm(x, axis=-1), A_wqkv, A_wo)
    h2 = h + _B_ref(_layernorm(h, axis=-1), B_w_r, B_w_gate, B_w_up, B_w_down)
    return h2
```

```asm
; @launch grid=(256,1,1) block=(512,1,1) lds=163840
.amdgcn_target "amdgcn-amd-amdhsa--gfx950"
.text
.globl sequential_preLN__sliding_block__moe_arch_mod__prompt_kernel
.p2align 8
.type sequential_preLN__sliding_block__moe_arch_mod__prompt_kernel,@function
sequential_preLN__sliding_block__moe_arch_mod__prompt_kernel:
    s_cmp_ge_u32 s2, 256
    s_cbranch_scc1 L_end
    s_load_dwordx16 s[4:19], s[0:1], 0
    s_load_dwordx4 s[20:23], s[0:1], 64
    s_load_dwordx2 s[24:25], s[0:1], 80
    s_memrealtime s[26:27]

    v_lshrrev_b32 v1, 6, v0
    s_getpc_b64 s[76:77]
    v_readfirstlane_b32 s71, v1
    v_and_b32 v0, 63, v0
    s_lshr_b32 s74, s2, 3
    s_mul_i32 s78, s74, 768
    s_mul_i32 s75, s71, 2048
    s_cmp_eq_u32 s71, 3
    s_cselect_b32 s78, s78, s75
    s_cselect_b32 s75, 6, 16
    s_cmp_lt_u32 s71, 4
    s_cbranch_scc0 L_nocp
    v_lshl_add_u32 v2, v0, 7, s78
    s_bfm_b64 exec, s75, 0
    global_load_dword v81, v2, s[76:77]
    s_mov_b64 exec, -1
L_nocp:
    s_and_b32 s73, s2, 7
    s_and_b32 s75, s74, 3
    s_lshl_b32 s68, s73, 2
    s_lshr_b32 s69, s74, 2
    s_add_u32 s76, s68, s69
    s_add_u32 s68, s68, s75
    s_and_b32 s76, s76, 7
    s_mul_i32 s76, s76, 0x11111111
    s_mul_i32 s75, s75, 0x11111111
    s_add_u32 s75, s75, 0x32132100
    s_and_b32 s75, s75, 0x33333333
    s_add_u32 s75, s75, 0x44400040
    s_add_u32 s70, s75, s76
    s_mul_i32 s76, s2, 6144
    s_mul_i32 s75, s71, 768
    s_add_u32 s76, s75, s76
    v_lshlrev_b32 v1, 4, v0
    s_cmp_lt_u32 s71, 4
    s_cbranch_scc1 L_main

    v_lshrrev_b32 v8, 3, v0
    v_and_b32 v9, 7, v0
    v_lshrrev_b32 v10, 4, v0
    v_xor_b32 v10, v10, v9
    v_lshlrev_b32 v10, 4, v10
    v_lshl_add_u32 v2, v8, 10, v10
    v_xor_b32 v10, 64, v2
    v_add_u32 v3, 7168, v10
    s_and_b32 s78, s71, 3
    s_lshl_b32 s79, s68, 16
    s_lshl_b32 s75, s78, 14
    s_add_u32 s79, s79, s75
    s_lshl_b32 s78, s78, 11
    s_mov_b32 s30, 2097152
    s_mov_b32 s31, 0x20000
    s_waitcnt lgkmcnt(0)

    s_mov_b64 s[28:29], s[4:5]
    s_add_u32 m0, s78, 0
    s_bfe_u32 s100, s70, 196608
    s_lshl_b32 s100, s100, 7
    s_add_u32 s100, s100, s79
    buffer_load_dwordx4 v2, s[28:31], s100 offen offset:0 lds
    buffer_load_dwordx4 v3, s[28:31], s100 offen offset:1024 lds
    s_add_u32 m0, s78, 8192
    s_bfe_u32 s100, s70, 196612
    s_lshl_b32 s100, s100, 7
    s_add_u32 s100, s100, s79
    buffer_load_dwordx4 v2, s[28:31], s100 offen offset:0 lds
    buffer_load_dwordx4 v3, s[28:31], s100 offen offset:1024 lds
    s_add_u32 m0, s78, 16384
    s_bfe_u32 s100, s70, 196616
    s_lshl_b32 s100, s100, 7
    s_add_u32 s100, s100, s79
    buffer_load_dwordx4 v2, s[28:31], s100 offen offset:0 lds
    buffer_load_dwordx4 v3, s[28:31], s100 offen offset:1024 lds
    s_add_u32 m0, s78, 24576
    s_bfe_u32 s100, s70, 196620
    s_lshl_b32 s100, s100, 7
    s_add_u32 s100, s100, s79
    buffer_load_dwordx4 v2, s[28:31], s100 offen offset:0 lds
    buffer_load_dwordx4 v3, s[28:31], s100 offen offset:1024 lds
    s_add_u32 m0, s78, 32768
    s_bfe_u32 s100, s70, 196624
    s_lshl_b32 s100, s100, 7
    s_add_u32 s100, s100, s79
    buffer_load_dwordx4 v2, s[28:31], s100 offen offset:0 lds
    buffer_load_dwordx4 v3, s[28:31], s100 offen offset:1024 lds
    s_mov_b64 s[32:33], s[6:7]
    s_mov_b32 s34, 1572864
    s_mov_b32 s35, 0x20000
    v_and_b32 v10, 2, v8
    v_lshlrev_b32 v10, 1, v10
    v_xor_b32 v10, v9, v10
    v_lshlrev_b32 v10, 4, v10
    v_mul_u32_u24 v11, 3072, v8
    v_add_u32 v4, v10, v11
    v_add_u32 v5, 23552, v4
    s_mul_i32 s4, s78, 24
    s_lshl_b32 s75, s69, 7
    s_add_u32 s4, s4, s75
    s_add_u32 s5, s4, 1024
    s_add_u32 s6, s4, 2048

    s_mov_b64 s[36:37], s[8:9]
    s_mov_b32 s38, 524288
    s_mov_b32 s39, 0x20000
    s_mov_b64 s[60:61], s[12:13]
    s_mov_b32 s62, 1024
    s_mov_b32 s63, 0x20000
    s_mov_b64 s[48:49], s[14:15]
    s_mov_b32 s50, 1835008
    s_mov_b32 s51, 0x20000
    s_mov_b64 s[52:53], s[16:17]
    s_mov_b32 s54, 1835008
    s_mov_b32 s55, 0x20000
    s_mov_b64 s[56:57], s[18:19]
    s_mov_b32 s58, 1835008
    s_mov_b32 s59, 0x20000
    s_mov_b64 s[44:45], s[20:21]
    s_mov_b32 s46, 2097152
    s_mov_b32 s47, 0x20000
    s_mov_b64 s[40:41], s[24:25]
    s_mov_b32 s42, 9437184
    s_mov_b32 s43, 0x20000
    s_mov_b64 s[20:21], s[22:23]
    v_mov_b32 v81, 0
    s_lshl_b32 s75, s68, 7
    s_lshl_b32 s76, s69, 2
    s_add_u32 s75, s75, s76
    s_add_u32 s22, s75, 7413760
    v_and_b32 v10, 6, v8
    v_xor_b32 v10, v9, v10
    v_lshlrev_b32 v10, 4, v10
    v_lshl_add_u32 v6, v8, 10, v10
    v_add_u32 v7, 7168, v6
    v_and_b32 v8, 31, v0
    v_lshrrev_b32 v9, 5, v0
    v_lshlrev_b32 v9, 2, v9
    v_sub_u32 v8, v8, v9
    s_lshr_b32 s75, s78, 8
    v_subrev_u32 v9, s75, v8
    v_cvt_f32_i32 v8, v8
    v_cvt_f32_i32 v9, v9
    v_mov_b32 v10, 0x71800000
    v_mov_b32 v11, 0xf1800000
    v_fmaak_f32 v16, v9, v10, 0x71000000
    v_fmaak_f32 v17, v9, v10, 0xf1000000
    v_fmaak_f32 v18, v9, v10, 0xf1c00000
    v_fmaak_f32 v19, v9, v10, 0xf2200000
    v_min_f32 v16, 0, v16
    v_min_f32 v17, 0, v17
    v_min_f32 v18, 0, v18
    v_min_f32 v19, 0, v19
    s_lshr_b32 s75, s78, 1
    s_add_u32 s75, s75, 147456
    v_add_u32 v9, s75, v1
    ds_write_b128 v9, v[16:19]
    v_fmaak_f32 v88, v8, v11, 0xf1000000
    v_fmaak_f32 v89, v8, v11, 0x71000000
    v_fmaak_f32 v90, v8, v11, 0x71c00000
    v_fmaak_f32 v91, v8, v11, 0x72200000
    v_fmaak_f32 v92, v8, v11, 0x72f00000
    v_fmaak_f32 v93, v8, v11, 0x73080000
    v_fmaak_f32 v94, v8, v11, 0x73180000
    v_fmaak_f32 v95, v8, v11, 0x73280000
    v_fmaak_f32 v96, v8, v11, 0x73780000
    v_fmaak_f32 v97, v8, v11, 0x73840000
    v_fmaak_f32 v98, v8, v11, 0x738c0000
    v_fmaak_f32 v99, v8, v11, 0x73940000
    v_fmaak_f32 v100, v8, v11, 0x73bc0000
    v_fmaak_f32 v101, v8, v11, 0x73c40000
    v_fmaak_f32 v102, v8, v11, 0x73cc0000
    v_fmaak_f32 v103, v8, v11, 0x73d40000
    v_min_f32 v88, 0, v88
    v_min_f32 v89, 0, v89
    v_min_f32 v90, 0, v90
    v_min_f32 v91, 0, v91
    v_min_f32 v92, 0, v92
    v_min_f32 v93, 0, v93
    v_min_f32 v94, 0, v94
    v_min_f32 v95, 0, v95
    v_min_f32 v96, 0, v96
    v_min_f32 v97, 0, v97
    v_min_f32 v98, 0, v98
    v_min_f32 v99, 0, v99
    v_min_f32 v100, 0, v100
    v_min_f32 v101, 0, v101
    v_min_f32 v102, 0, v102
    v_min_f32 v103, 0, v103
    s_and_b32 s75, s71, 3
    s_lshl_b32 s18, s68, 1
    s_lshl_b32 s19, s69, 19
    s_lshl_b32 s75, s75, 11
    s_add_u32 s19, s19, s75
    s_mov_b32 s10, 0xffff
    s_mov_b32 s11, 0xffff
    s_add_i32 s75, s18, -8
    s_lshl_b32 s76, s75, 13
    s_add_u32 s76, s76, s19
    s_cmp_ge_i32 s75, 0
    s_cselect_b32 s76, s76, 2147483648
    s_cselect_b32 s14, 0x3f803f80, 0
    s_mov_b32 s15, s14
    v_add_u32 v104, s76, v1
    v_mov_b64 v[112:113], s[14:15]
    s_waitcnt vmcnt(8)
    s_barrier
    s_add_u32 m0, s78, 40960
    s_bfe_u32 s100, s70, 196628
    s_lshl_b32 s100, s100, 7
    s_add_u32 s100, s100, s79
    buffer_load_dwordx4 v2, s[28:31], s100 offen offset:0 lds
    buffer_load_dwordx4 v3, s[28:31], s100 offen offset:1024 lds
    s_waitcnt vmcnt(8)
    s_barrier
    s_add_u32 m0, s78, 49152
    s_bfe_u32 s100, s70, 196632
    s_lshl_b32 s100, s100, 7
    s_add_u32 s100, s100, s79
    buffer_load_dwordx4 v2, s[28:31], s100 offen offset:0 lds
    buffer_load_dwordx4 v3, s[28:31], s100 offen offset:1024 lds
    s_waitcnt vmcnt(8)
    s_barrier
    s_add_u32 m0, s78, 0
    s_bfe_u32 s100, s70, 196636
    s_lshl_b32 s100, s100, 7
    s_add_u32 s100, s100, s79
    buffer_load_dwordx4 v2, s[28:31], s100 offen offset:0 lds
    buffer_load_dwordx4 v3, s[28:31], s100 offen offset:1024 lds
    s_waitcnt vmcnt(8)
    s_barrier
    s_add_u32 m0, s78, 8192
    s_bfe_u32 s100, s70, 196608
    s_mul_i32 s100, s100, 196608
    s_add_u32 s100, s100, s5
    buffer_load_dwordx4 v4, s[32:35], s100 offen offset:0 lds
    buffer_load_dwordx4 v5, s[32:35], s100 offen offset:1024 lds
    s_waitcnt vmcnt(8)
    s_barrier
    s_add_u32 m0, s78, 16384
    s_bfe_u32 s100, s70, 196612
    s_mul_i32 s100, s100, 196608
    s_add_u32 s100, s100, s5
    buffer_load_dwordx4 v4, s[32:35], s100 offen offset:0 lds
    buffer_load_dwordx4 v5, s[32:35], s100 offen offset:1024 lds
    v_mov_b64 v[114:115], s[14:15]
    v_mov_b64 v[116:117], s[14:15]
    v_mov_b64 v[118:119], s[14:15]
    s_add_i32 s75, s18, -7
    s_lshl_b32 s76, s75, 13
    s_add_u32 s76, s76, s19
    s_cmp_ge_i32 s75, 0
    s_cselect_b32 s76, s76, 2147483648
    s_cselect_b32 s14, 0x3f803f80, 0
    s_mov_b32 s15, s14
    v_add_u32 v105, s76, v1
    v_mov_b64 v[120:121], s[14:15]
    v_mov_b64 v[122:123], s[14:15]
    v_mov_b64 v[124:125], s[14:15]
    v_mov_b64 v[126:127], s[14:15]
    s_add_i32 s75, s18, -6
    s_lshl_b32 s76, s75, 13
    s_add_u32 s76, s76, s19
    s_cmp_ge_i32 s75, 0
    s_cselect_b32 s76, s76, 2147483648
    s_cselect_b32 s14, 0x3f803f80, 0
    s_mov_b32 s15, s14
    global_load_dword v80, v81, s[20:21] sc1
    s_waitcnt vmcnt(9)
    s_barrier
    s_add_u32 m0, s78, 24576
    s_bfe_u32 s100, s70, 196616
    s_mul_i32 s100, s100, 196608
    s_add_u32 s100, s100, s5
    buffer_load_dwordx4 v4, s[32:35], s100 offen offset:0 lds
    buffer_load_dwordx4 v5, s[32:35], s100 offen offset:1024 lds
    v_add_u32 v106, s76, v1
    v_mov_b64 v[128:129], s[14:15]
    v_mov_b64 v[130:131], s[14:15]
    v_mov_b64 v[132:133], s[14:15]
    v_mov_b64 v[134:135], s[14:15]
    s_add_i32 s75, s18, -5
    s_lshl_b32 s76, s75, 13
    s_add_u32 s76, s76, s19
    s_cmp_ge_i32 s75, 0
    s_cselect_b32 s76, s76, 2147483648
    s_cselect_b32 s14, 0x3f803f80, 0
    s_mov_b32 s15, s14
    v_add_u32 v107, s76, v1
    v_mov_b64 v[136:137], s[14:15]
    v_mov_b64 v[138:139], s[14:15]
    v_mov_b64 v[140:141], s[14:15]
    v_mov_b64 v[142:143], s[14:15]
    s_add_i32 s75, s18, -4
    s_lshl_b32 s76, s75, 13
    s_add_u32 s76, s76, s19
    s_waitcnt vmcnt(9)
    s_barrier
    s_add_u32 m0, s78, 32768
    s_bfe_u32 s100, s70, 196620
    s_mul_i32 s100, s100, 196608
    s_add_u32 s100, s100, s5
    buffer_load_dwordx4 v4, s[32:35], s100 offen offset:0 lds
    buffer_load_dwordx4 v5, s[32:35], s100 offen offset:1024 lds
    s_cmp_ge_i32 s75, 0
    s_cselect_b32 s76, s76, 2147483648
    s_cselect_b32 s14, 0x3f803f80, 0
    s_mov_b32 s15, s14
    v_add_u32 v108, s76, v1
    v_mov_b64 v[144:145], s[14:15]
    v_mov_b64 v[146:147], s[14:15]
    v_mov_b64 v[148:149], s[14:15]
    v_mov_b64 v[150:151], s[14:15]
    s_lshl_b32 s75, s69, 12
    s_lshl_b32 s76, s68, 7
    s_add_u32 s75, s75, s76
    s_add_u32 s75, s75, 7339520
    v_lshl_add_u32 v83, v0, 7, s75
    s_min_u32 s75, s68, 4
    s_lshl_b32 s75, s75, 2
    s_lshr_b32 s12, 0x76400, s75
    s_and_b32 s12, s12, 7
    s_mov_b32 s13, 0
    s_and_b32 s16, s74, 3
    s_waitcnt vmcnt(9)
    s_barrier
    s_add_u32 m0, s78, 40960
    s_bfe_u32 s100, s70, 196624
    s_mul_i32 s100, s100, 196608
    s_add_u32 s100, s100, s5
    buffer_load_dwordx4 v4, s[32:35], s100 offen offset:0 lds
    buffer_load_dwordx4 v5, s[32:35], s100 offen offset:1024 lds
    s_lshl_b32 s16, s16, 1
    s_lshl_b32 s17, s78, 3
    s_lshl_b32 s75, s69, 7
    s_add_u32 s17, s17, s75
    s_lshr_b32 s75, s78, 1
    s_add_u32 s75, s75, 139264
    v_add_u32 v8, s75, v1
    s_lshl_b32 s75, s68, 7
    s_add_u32 s75, s75, 7413728
    v_lshl_add_u32 v84, v0, 2, s75
    s_mov_b64 exec, 0xff
    v_add_u32 v84, 0x8000, v83
    s_mov_b64 exec, -1
    s_lshr_b32 s75, s68, 3
    s_sub_u32 s23, s68, s75
    s_mul_i32 s64, s69, 229376
    s_mul_i32 s75, s78, 28
    s_add_u32 s64, s64, s75
    s_lshl_b32 s75, s23, 7
    s_add_u32 s64, s64, s75
    s_waitcnt vmcnt(9)
    s_barrier
    s_add_u32 s65, s64, 27648
    s_lshl_b32 s66, s23, 16
    s_add_u32 s66, s66, s17
    s_add_u32 s67, s66, 7168
    s_and_b32 s75, s68, 7
    s_cmp_eq_u32 s75, 7
    s_cselect_b32 s76, 2147483648, 0
    v_lshrrev_b32 v9, 3, v0
    v_add_u32 v110, s76, v6
    v_mul_u32_u24 v9, 2560, v9
    v_add_u32 v109, v9, v110
    s_lshl_b32 s75, s68, 16
    s_lshl_b32 s76, s69, 12
    s_add_u32 s75, s75, s76
    s_lshr_b32 s76, s78, 1
    s_add_u32 s75, s75, s76
    s_add_u32 s75, s75, 4194304
    v_lshl_add_u32 v111, v0, 7, s75
    s_mov_b64 exec, 0xff00
    v_add_u32 v111, 31744, v111
    s_mov_b64 exec, -1
    s_waitcnt vmcnt(7)
    s_barrier
    s_lshl_b32 s75, s68, 13
    s_add_u32 s75, s75, s78
    s_lshl_b32 s76, s69, 8
    s_add_u32 s75, s75, s76
    s_add_u32 s75, s75, 6289408
    s_mov_b64 exec, 0x30000
    v_lshl_add_u32 v111, v0, 7, s75
    s_mov_b64 exec, -1
    s_lshl_b32 s75, s23, 13
    s_lshl_b32 s76, s69, 10
    s_add_u32 s75, s75, s76
    s_lshr_b32 s76, s78, 3
    s_add_u32 s75, s75, s76
    s_add_u32 s75, s75, 7554816
    s_mov_b64 exec, 0xc0000
    v_lshl_add_u32 v111, v0, 7, s75
    s_mov_b64 exec, -1
    s_lshl_b32 s75, s68, 8
    s_add_u32 s75, s75, 7403008
    s_mov_b64 exec, 0x300000
    v_lshl_add_u32 v111, v0, 7, s75
    s_mov_b64 exec, -1
    s_waitcnt vmcnt(4)
    s_barrier
    s_add_u32 m0, s78, 49152
    s_bfe_u32 s100, s70, 196628
    s_mul_i32 s100, s100, 196608
    s_add_u32 s100, s100, s5
    buffer_load_dwordx4 v4, s[32:35], s100 offen offset:0 lds
    buffer_load_dwordx4 v5, s[32:35], s100 offen offset:1024 lds
    s_add_u32 m0, s78, 0
    s_bfe_u32 s100, s70, 196632
    s_mul_i32 s100, s100, 196608
    s_add_u32 s100, s100, s5
    buffer_load_dwordx4 v4, s[32:35], s100 offen offset:0 lds
    buffer_load_dwordx4 v5, s[32:35], s100 offen offset:1024 lds
    s_add_u32 m0, s78, 8192
    s_bfe_u32 s100, s70, 196636
    s_mul_i32 s100, s100, 196608
    s_add_u32 s100, s100, s5
    buffer_load_dwordx4 v4, s[32:35], s100 offen offset:0 lds
    buffer_load_dwordx4 v5, s[32:35], s100 offen offset:1024 lds
    s_waitcnt vmcnt(8)
    s_barrier
    s_add_u32 m0, s78, 16384
    s_bfe_u32 s100, s70, 196608
    s_mul_i32 s100, s100, 196608
    s_add_u32 s100, s100, s6
    buffer_load_dwordx4 v4, s[32:35], s100 offen offset:0 lds
    buffer_load_dwordx4 v5, s[32:35], s100 offen offset:1024 lds
    s_waitcnt vmcnt(8)
    s_barrier
    s_add_u32 m0, s78, 24576
    s_bfe_u32 s100, s70, 196612
    s_mul_i32 s100, s100, 196608
    s_add_u32 s100, s100, s6
    buffer_load_dwordx4 v4, s[32:35], s100 offen offset:0 lds
    buffer_load_dwordx4 v5, s[32:35], s100 offen offset:1024 lds
    s_mov_b32 s76, 200000
    s_getreg_b32 s79, hwreg(HW_REG_XCC_ID, 0, 4)
L_tagspin:
    v_readfirstlane_b32 s72, v80
    s_cmp_lg_u32 s72, 0
    s_cbranch_scc1 L_tagok
    global_load_dword v80, v81, s[20:21] sc1
    s_sub_u32 s76, s76, 1
    s_cmp_lg_u32 s76, 0
    s_waitcnt vmcnt(0)
    s_cbranch_scc1 L_tagspin
L_tagok:
    s_lshl_b32 s79, s79, 28
    s_xor_b32 s79, s79, s72
    v_mov_b32 v10, 153088
    v_mov_b32 v81, s79
    s_cmp_eq_u32 s78, 0
    s_cselect_b64 exec, 1, 0
    ds_write_b64 v10, v[80:81]

    buffer_store_dword v81, v1, s[40:43], s22 offen sc1
    s_mov_b64 exec, -1
    s_waitcnt vmcnt(9)
    s_barrier
    s_add_u32 m0, s78, 32768
    s_bfe_u32 s100, s70, 196616
    s_mul_i32 s100, s100, 196608
    s_add_u32 s100, s100, s6
    buffer_load_dwordx4 v4, s[32:35], s100 offen offset:0 lds
    buffer_load_dwordx4 v5, s[32:35], s100 offen offset:1024 lds
    s_waitcnt vmcnt(9)
    s_barrier
    s_add_u32 m0, s78, 40960
    s_bfe_u32 s100, s70, 196620
    s_mul_i32 s100, s100, 196608
    s_add_u32 s100, s100, s6
    buffer_load_dwordx4 v4, s[32:35], s100 offen offset:0 lds
    buffer_load_dwordx4 v5, s[32:35], s100 offen offset:1024 lds
    s_waitcnt vmcnt(9)
    s_barrier
    s_add_u32 m0, s78, 49152
    s_bfe_u32 s100, s70, 196624
    s_mul_i32 s100, s100, 196608
    s_add_u32 s100, s100, s6
    buffer_load_dwordx4 v4, s[32:35], s100 offen offset:0 lds
    buffer_load_dwordx4 v5, s[32:35], s100 offen offset:1024 lds
    s_waitcnt vmcnt(9)
    s_barrier
    s_add_u32 m0, s78, 0
    s_bfe_u32 s100, s70, 196628
    s_mul_i32 s100, s100, 196608
    s_add_u32 s100, s100, s6
    buffer_load_dwordx4 v4, s[32:35], s100 offen offset:0 lds
    buffer_load_dwordx4 v5, s[32:35], s100 offen offset:1024 lds
    s_waitcnt vmcnt(9)
    s_barrier
    s_add_u32 m0, s78, 8192
    s_bfe_u32 s100, s70, 196632
    s_mul_i32 s100, s100, 196608
    s_add_u32 s100, s100, s6
    buffer_load_dwordx4 v4, s[32:35], s100 offen offset:0 lds
    buffer_load_dwordx4 v5, s[32:35], s100 offen offset:1024 lds
    s_waitcnt vmcnt(8)
    s_barrier
    s_add_u32 m0, s78, 16384
    s_bfe_u32 s100, s70, 196636
    s_mul_i32 s100, s100, 196608
    s_add_u32 s100, s100, s6
    buffer_load_dwordx4 v4, s[32:35], s100 offen offset:0 lds
    buffer_load_dwordx4 v5, s[32:35], s100 offen offset:1024 lds
    s_waitcnt lgkmcnt(0)
    s_waitcnt vmcnt(8)
    s_barrier
    s_add_u32 m0, s78, 24576
    s_bfe_u32 s100, s70, 196608
    s_mul_i32 s100, s100, 196608
    s_add_u32 s100, s100, s4
    buffer_load_dwordx4 v4, s[32:35], s100 offen offset:0 lds
    buffer_load_dwordx4 v5, s[32:35], s100 offen offset:1024 lds
    s_waitcnt vmcnt(8)
    s_barrier
    s_add_u32 m0, s78, 32768
    s_bfe_u32 s100, s70, 196612
    s_mul_i32 s100, s100, 196608
    s_add_u32 s100, s100, s4
    buffer_load_dwordx4 v4, s[32:35], s100 offen offset:0 lds
    buffer_load_dwordx4 v5, s[32:35], s100 offen offset:1024 lds
    s_waitcnt vmcnt(8)
    s_barrier
    s_add_u32 m0, s78, 40960
    s_bfe_u32 s100, s70, 196616
    s_mul_i32 s100, s100, 196608
    s_add_u32 s100, s100, s4
    buffer_load_dwordx4 v4, s[32:35], s100 offen offset:0 lds
    buffer_load_dwordx4 v5, s[32:35], s100 offen offset:1024 lds
    s_waitcnt vmcnt(8)
    s_barrier
    s_add_u32 m0, s78, 49152
    s_bfe_u32 s100, s70, 196620
    s_mul_i32 s100, s100, 196608
    s_add_u32 s100, s100, s4
    buffer_load_dwordx4 v4, s[32:35], s100 offen offset:0 lds
    buffer_load_dwordx4 v5, s[32:35], s100 offen offset:1024 lds
    s_waitcnt vmcnt(8)
    s_barrier
    s_add_u32 m0, s78, 0
    s_bfe_u32 s100, s70, 196624
    s_mul_i32 s100, s100, 196608
    s_add_u32 s100, s100, s4
    buffer_load_dwordx4 v4, s[32:35], s100 offen offset:0 lds
    buffer_load_dwordx4 v5, s[32:35], s100 offen offset:1024 lds
    s_waitcnt vmcnt(8)
    s_barrier
    s_add_u32 m0, s78, 8192
    s_bfe_u32 s100, s70, 196628
    s_mul_i32 s100, s100, 196608
    s_add_u32 s100, s100, s4
    buffer_load_dwordx4 v4, s[32:35], s100 offen offset:0 lds
    buffer_load_dwordx4 v5, s[32:35], s100 offen offset:1024 lds
    s_waitcnt vmcnt(8)
    s_barrier
    s_add_u32 m0, s78, 16384
    s_bfe_u32 s100, s70, 196632
    s_mul_i32 s100, s100, 196608
    s_add_u32 s100, s100, s4
    buffer_load_dwordx4 v4, s[32:35], s100 offen offset:0 lds
    buffer_load_dwordx4 v5, s[32:35], s100 offen offset:1024 lds
    s_waitcnt vmcnt(8)
    s_barrier
    s_add_u32 m0, s78, 24576
    s_bfe_u32 s100, s70, 196636
    s_mul_i32 s100, s100, 196608
    s_add_u32 s100, s100, s4
    buffer_load_dwordx4 v4, s[32:35], s100 offen offset:0 lds
    buffer_load_dwordx4 v5, s[32:35], s100 offen offset:1024 lds
    s_waitcnt vmcnt(8)
    s_barrier
    s_add_u32 s75, s16, 0
    s_and_b32 s75, s75, 7
    s_lshl_b32 s76, s75, 13
    s_add_u32 s76, s76, s78
    s_add_u32 m0, s76, 57344
    s_add_u32 s75, s75, s69
    s_and_b32 s75, s75, 7
    s_lshl_b32 s75, s75, 16
    s_add_u32 s75, s75, s17

    buffer_load_dwordx4 v6, s[36:39], s75 offen offset:0 lds
    buffer_load_dwordx4 v7, s[36:39], s75 offen offset:1024 lds
    s_lshr_b32 s75, s78, 3
    s_add_u32 m0, s75, 151552
    s_mov_b64 exec, 0xffff
    buffer_load_dwordx4 v1, s[60:63], s75 offen lds
    s_mov_b64 exec, -1
    s_waitcnt vmcnt(9)
    s_barrier
    s_add_u32 s75, s16, 1
    s_and_b32 s75, s75, 7
    s_lshl_b32 s76, s75, 13
    s_add_u32 s76, s76, s78
    s_add_u32 m0, s76, 57344
    s_add_u32 s75, s75, s69
    s_and_b32 s75, s75, 7
    s_lshl_b32 s75, s75, 16
    s_add_u32 s75, s75, s17

    buffer_load_dwordx4 v6, s[36:39], s75 offen offset:0 lds
    buffer_load_dwordx4 v7, s[36:39], s75 offen offset:1024 lds
    s_mov_b64 exec, 7
    buffer_load_dword v82, v83, s[40:43], 0 offen sc1
    s_mov_b64 exec, -1
    s_waitcnt vmcnt(10)
    s_barrier
    s_add_u32 s75, s16, 2
    s_and_b32 s75, s75, 7
    s_lshl_b32 s76, s75, 13
    s_add_u32 s76, s76, s78
    s_add_u32 m0, s76, 57344
    s_add_u32 s75, s75, s69
    s_and_b32 s75, s75, 7
    s_lshl_b32 s75, s75, 16
    s_add_u32 s75, s75, s17

    buffer_load_dwordx4 v6, s[36:39], s75 offen offset:0 lds
    buffer_load_dwordx4 v7, s[36:39], s75 offen offset:1024 lds
    s_waitcnt vmcnt(10)
    s_barrier
    s_add_u32 s75, s16, 3
    s_and_b32 s75, s75, 7
    s_lshl_b32 s76, s75, 13
    s_add_u32 s76, s76, s78
    s_add_u32 m0, s76, 57344
    s_add_u32 s75, s75, s69
    s_and_b32 s75, s75, 7
    s_lshl_b32 s75, s75, 16
    s_add_u32 s75, s75, s17

    buffer_load_dwordx4 v6, s[36:39], s75 offen offset:0 lds
    buffer_load_dwordx4 v7, s[36:39], s75 offen offset:1024 lds
    s_waitcnt vmcnt(10)
    s_barrier
    s_waitcnt vmcnt(4)
    v_cmp_ne_u32 vcc, s72, v82
    s_and_b64 vcc, vcc, s[12:13]
    s_cbranch_vccnz L_lkfail

    buffer_load_dwordx4 v[152:155], v104, s[40:43], 0 offen sc1
    buffer_load_dwordx4 v[156:159], v105, s[40:43], 0 offen sc1
    buffer_load_dwordx4 v[160:163], v106, s[40:43], 0 offen sc1
    buffer_load_dwordx4 v[164:167], v107, s[40:43], 0 offen sc1
    buffer_load_dwordx4 v[168:171], v108, s[40:43], 0 offen sc1
    s_add_u32 s75, s16, 4
    s_and_b32 s75, s75, 7
    s_lshl_b32 s76, s75, 13
    s_add_u32 s76, s76, s78
    s_add_u32 m0, s76, 57344
    s_add_u32 s75, s75, s69
    s_and_b32 s75, s75, 7
    s_lshl_b32 s75, s75, 16
    s_add_u32 s75, s75, s17

    buffer_load_dwordx4 v6, s[36:39], s75 offen offset:0 lds
    buffer_load_dwordx4 v7, s[36:39], s75 offen offset:1024 lds
    s_add_u32 s75, s16, 5
    s_and_b32 s75, s75, 7
    s_lshl_b32 s76, s75, 13
    s_add_u32 s76, s76, s78
    s_add_u32 m0, s76, 57344
    s_add_u32 s75, s75, s69
    s_and_b32 s75, s75, 7
    s_lshl_b32 s75, s75, 16
    s_add_u32 s75, s75, s17

    buffer_load_dwordx4 v6, s[36:39], s75 offen offset:0 lds
    buffer_load_dwordx4 v7, s[36:39], s75 offen offset:1024 lds
    s_add_u32 s75, s16, 6
    s_and_b32 s75, s75, 7
    s_lshl_b32 s76, s75, 13
    s_add_u32 s76, s76, s78
    s_add_u32 m0, s76, 57344
    s_add_u32 s75, s75, s69
    s_and_b32 s75, s75, 7
    s_lshl_b32 s75, s75, 16
    s_add_u32 s75, s75, s17

    buffer_load_dwordx4 v6, s[36:39], s75 offen offset:0 lds
    buffer_load_dwordx4 v7, s[36:39], s75 offen offset:1024 lds
    s_add_u32 s75, s16, 7
    s_and_b32 s75, s75, 7
    s_lshl_b32 s76, s75, 13
    s_add_u32 s76, s76, s78
    s_add_u32 m0, s76, 57344
    s_add_u32 s75, s75, s69
    s_and_b32 s75, s75, 7
    s_lshl_b32 s75, s75, 16
    s_add_u32 s75, s75, s17

    buffer_load_dwordx4 v6, s[36:39], s75 offen offset:0 lds
    buffer_load_dwordx4 v7, s[36:39], s75 offen offset:1024 lds
    s_barrier
    s_branch L_latt
L_lkfail:
    s_barrier
    s_mov_b64 exec, s[12:13]

    s_mov_b32 s76, 200000
L_lk:
    buffer_load_dword v82, v83, s[40:43], 0 offen sc1
    s_waitcnt vmcnt(0)
    v_cmp_ne_u32 vcc, s72, v82
    s_cbranch_vccz L_lkok
    s_sub_u32 s76, s76, 1
    s_cmp_lg_u32 s76, 0
    s_cbranch_scc1 L_lk
L_lkok:
    s_mov_b64 exec, -1
    buffer_load_dwordx4 v[152:155], v104, s[40:43], 0 offen sc1
    buffer_load_dwordx4 v[156:159], v105, s[40:43], 0 offen sc1
    buffer_load_dwordx4 v[160:163], v106, s[40:43], 0 offen sc1
    buffer_load_dwordx4 v[164:167], v107, s[40:43], 0 offen sc1
    buffer_load_dwordx4 v[168:171], v108, s[40:43], 0 offen sc1
    s_add_u32 s75, s16, 4
    s_and_b32 s75, s75, 7
    s_lshl_b32 s76, s75, 13
    s_add_u32 s76, s76, s78
    s_add_u32 m0, s76, 57344
    s_add_u32 s75, s75, s69
    s_and_b32 s75, s75, 7
    s_lshl_b32 s75, s75, 16
    s_add_u32 s75, s75, s17

    buffer_load_dwordx4 v6, s[36:39], s75 offen offset:0 lds
    buffer_load_dwordx4 v7, s[36:39], s75 offen offset:1024 lds
    s_add_u32 s75, s16, 5
    s_and_b32 s75, s75, 7
    s_lshl_b32 s76, s75, 13
    s_add_u32 s76, s76, s78
    s_add_u32 m0, s76, 57344
    s_add_u32 s75, s75, s69
    s_and_b32 s75, s75, 7
    s_lshl_b32 s75, s75, 16
    s_add_u32 s75, s75, s17

    buffer_load_dwordx4 v6, s[36:39], s75 offen offset:0 lds
    buffer_load_dwordx4 v7, s[36:39], s75 offen offset:1024 lds
    s_add_u32 s75, s16, 6
    s_and_b32 s75, s75, 7
    s_lshl_b32 s76, s75, 13
    s_add_u32 s76, s76, s78
    s_add_u32 m0, s76, 57344
    s_add_u32 s75, s75, s69
    s_and_b32 s75, s75, 7
    s_lshl_b32 s75, s75, 16
    s_add_u32 s75, s75, s17

    buffer_load_dwordx4 v6, s[36:39], s75 offen offset:0 lds
    buffer_load_dwordx4 v7, s[36:39], s75 offen offset:1024 lds
    s_add_u32 s75, s16, 7
    s_and_b32 s75, s75, 7
    s_lshl_b32 s76, s75, 13
    s_add_u32 s76, s76, s78
    s_add_u32 m0, s76, 57344
    s_add_u32 s75, s75, s69
    s_and_b32 s75, s75, 7
    s_lshl_b32 s75, s75, 16
    s_add_u32 s75, s75, s17

    buffer_load_dwordx4 v6, s[36:39], s75 offen offset:0 lds
    buffer_load_dwordx4 v7, s[36:39], s75 offen offset:1024 lds
    s_branch L_latt
L_main:

    v_and_b32 v8, 31, v0
    v_lshrrev_b32 v9, 5, v0
    v_bfe_u32 v10, v0, 1, 3
    v_xor_b32 v10, v10, v9
    v_lshlrev_b32 v10, 4, v10
    v_lshl_add_u32 v11, v8, 7, v10
    s_and_b32 s75, s71, 1
    s_mul_i32 s75, s75, 4160
    s_and_b32 s78, s71, 2
    s_lshl_b32 s78, s78, 4
    s_add_u32 s75, s75, s78
    v_xor_b32 v2, s75, v11
    v_xor_b32 v3, 32, v2
    v_xor_b32 v4, 64, v2
    v_xor_b32 v5, 0x60, v2

    s_or_b32 s75, s2, s71
    s_cmp_lg_u32 s75, 0
    s_waitcnt lgkmcnt(0)

    s_mov_b64 s[64:65], s[22:23]
    s_mov_b32 s66, 256
    s_mov_b32 s67, 0x20000
    s_cbranch_scc1 L_notag
    s_or_b32 s26, s26, 1
    v_mov_b32 v12, s26
    v_lshlrev_b32 v13, 8, v0
    buffer_store_dword v12, v13, s[64:67], 0 offen sc1
L_notag:

    s_mov_b64 s[28:29], s[6:7]
    s_mov_b64 s[30:31], s[8:9]
    s_lshl_b32 s75, s2, 1
    s_lshr_b32 s76, s71, 1
    s_add_u32 s75, s75, s76
    s_mul_i32 s75, s75, 3072
    s_and_b32 s76, s71, 1
    s_lshl_b32 s76, s76, 9
    s_add_u32 s75, s75, s76
    v_lshl_add_u32 v96, v0, 7, s75
    s_lshl_b32 s75, s2, 2
    s_add_u32 s75, s75, s71
    s_lshl_b32 s75, s75, 9
    v_lshl_add_u32 v97, v0, 7, s75

    v_and_b32 v8, 15, v0
    v_bfe_u32 v11, v0, 4, 1
    v_lshl_add_u32 v10, v11, 3, v10
    v_lshl_add_u32 v10, v8, 7, v10
    s_lshl_b32 s75, s71, 11
    v_add_u32 v16, s75, v10
    v_xor_b32 v17, 32, v16
    v_xor_b32 v18, 64, v16
    v_xor_b32 v19, 0x60, v16

    v_lshrrev_b32 v10, 2, v0
    v_xor_b32 v10, v10, v0
    v_and_b32 v10, 4, v10
    v_add_u32 v10, -1, v10
    v_and_b32 v248, 0x3f803f80, v10
    v_and_b32 v249, 0x3f803f80, v10
    v_and_b32 v250, 0x3f803f80, v10
    v_and_b32 v251, 0x3f803f80, v10
    s_mov_b64 s[40:41], s[24:25]
    s_mov_b32 s42, 9437184
    s_mov_b32 s43, 0x20000
    s_mov_b64 s[44:45], s[20:21]
    s_mov_b32 s46, 2097152
    s_mov_b32 s47, 0x20000
    v_lshlrev_b32 v7, 4, v8
    v_lshl_add_u32 v7, v11, 11, v7
    v_lshl_add_u32 v7, v9, 9, v7
    s_and_b32 s4, s71, 1
    s_lshr_b32 s5, s71, 1
    v_bfe_u32 v10, v0, 2, 2
    v_lshl_add_u32 v6, v9, 3, v10
    v_lshlrev_b32 v6, 7, v6
    v_and_b32 v10, 2, v10
    v_lshlrev_b32 v10, 5, v10
    v_lshlrev_b32 v8, 5, v11
    v_and_b32 v12, 3, v0
    v_lshl_add_u32 v8, v12, 3, v8
    s_lshl_b32 s75, s5, 6
    v_add_u32 v8, s75, v8
    v_xor_b32 v8, v8, v10
    v_add_u32 v6, v8, v6
    s_lshl_b32 s75, s4, 1
    s_add_u32 s75, s75, s5
    s_lshl_b32 s75, s75, 11
    v_add_u32 v6, s75, v6
    s_lshl_b32 s75, s71, 9
    s_add_u32 s75, s75, 155648
    v_lshl_add_u32 v14, v0, 3, s75
    v_mov_b32 v105, 0
    v_mov_b32 v109, 0
    v_mov_b32 v106, 0
    v_mov_b32 v110, 0
    v_mov_b32 v107, 0
    v_mov_b32 v111, 0
    s_lshl_b32 s7, s4, 13
    s_lshl_b32 s75, s5, 12
    s_add_u32 s7, s7, s75
    s_lshl_b32 s6, s69, 19
    s_lshl_b32 s75, s68, 14
    s_add_u32 s6, s6, s75
    s_add_u32 s6, s6, s7
    s_lshl_b32 s8, s69, 12
    s_lshl_b32 s75, s68, 7
    s_add_u32 s8, s8, s75
    s_add_u32 s11, s8, 7339776
    s_add_u32 s8, s8, 7340032
    s_cmp_eq_u32 s71, 0
    s_cselect_b32 s8, s8, 2147483648
    s_add_u32 s9, s8, 32768
    v_mov_b32 v84, s8
    v_mov_b32 v85, s9
    v_lshl_add_u32 v83, v0, 7, s11
    v_and_b32 v12, 3, v0
    v_cmp_eq_u32 s[12:13], 1, v12
    v_cmp_eq_u32 s[14:15], 2, v12
    v_cmp_eq_u32 s[16:17], 3, v12
    s_mov_b64 exec, 15
    global_load_dword v81, v96, s[28:29] offset:1024
    global_load_dword v81, v96, s[28:29] offset:2048
    global_load_dword v81, v96, s[28:29] offset:0
    global_load_dword v81, v97, s[30:31]
    s_mov_b64 exec, -1
    s_barrier
    s_bfe_u32 s100, s70, 196608
    s_cmp_lg_u32 s100, s69
    s_cbranch_scc1 L_nxk0
    ds_read_b64 v[240:241], v16 offset:0
    ds_read_b64 v[242:243], v17 offset:0
    ds_read_b64 v[244:245], v18 offset:0
    ds_read_b64 v[246:247], v19 offset:0
L_nxk0:
    ds_read_b128 v[112:115], v2 offset:0
    ds_read_b128 v[116:119], v3 offset:0
    ds_read_b128 v[120:123], v4 offset:0
    ds_read_b128 v[124:127], v5 offset:0
    s_barrier
    s_bfe_u32 s100, s70, 196612
    s_cmp_lg_u32 s100, s69
    s_cbranch_scc1 L_nxk1
    ds_read_b64 v[240:241], v16 offset:8192
    ds_read_b64 v[242:243], v17 offset:8192
    ds_read_b64 v[244:245], v18 offset:8192
    ds_read_b64 v[246:247], v19 offset:8192
L_nxk1:
    ds_read_b128 v[128:131], v2 offset:8192
    ds_read_b128 v[132:135], v3 offset:8192
    ds_read_b128 v[136:139], v4 offset:8192
    ds_read_b128 v[140:143], v5 offset:8192
    s_waitcnt lgkmcnt(4)
    v_mfma_f32_16x16x32_bf16 v[64:67], v[248:251], v[112:115], 0
    v_mfma_f32_4x4x4_16b_bf16 v[68:71], v[112:113], v[112:113], 0
    v_mfma_f32_4x4x4_16b_bf16 v[72:75], v[114:115], v[114:115], 0
    v_mfma_f32_16x16x32_bf16 v[64:67], v[248:251], v[120:123], v[64:67]
    v_mfma_f32_4x4x4_16b_bf16 v[68:71], v[120:121], v[120:121], v[68:71]
    v_mfma_f32_4x4x4_16b_bf16 v[72:75], v[122:123], v[122:123], v[72:75]
    s_barrier
    s_bfe_u32 s100, s70, 196616
    s_cmp_lg_u32 s100, s69
    s_cbranch_scc1 L_nxk2
    ds_read_b64 v[240:241], v16 offset:16384
    ds_read_b64 v[242:243], v17 offset:16384
    ds_read_b64 v[244:245], v18 offset:16384
    ds_read_b64 v[246:247], v19 offset:16384
L_nxk2:
    ds_read_b128 v[144:147], v2 offset:16384
    ds_read_b128 v[148:151], v3 offset:16384
    ds_read_b128 v[152:155], v4 offset:16384
    ds_read_b128 v[156:159], v5 offset:16384
    s_waitcnt lgkmcnt(4)
    v_mfma_f32_16x16x32_bf16 v[64:67], v[248:251], v[128:131], v[64:67]
    v_mfma_f32_4x4x4_16b_bf16 v[68:71], v[128:129], v[128:129], v[68:71]
    v_mfma_f32_4x4x4_16b_bf16 v[72:75], v[130:131], v[130:131], v[72:75]
    v_mfma_f32_16x16x32_bf16 v[64:67], v[248:251], v[136:139], v[64:67]
    v_mfma_f32_4x4x4_16b_bf16 v[68:71], v[136:137], v[136:137], v[68:71]
    v_mfma_f32_4x4x4_16b_bf16 v[72:75], v[138:139], v[138:139], v[72:75]
    s_barrier
    s_bfe_u32 s100, s70, 196620
    s_cmp_lg_u32 s100, s69
    s_cbranch_scc1 L_nxk3
    ds_read_b64 v[240:241], v16 offset:24576
    ds_read_b64 v[242:243], v17 offset:24576
    ds_read_b64 v[244:245], v18 offset:24576
    ds_read_b64 v[246:247], v19 offset:24576
L_nxk3:
    ds_read_b128 v[160:163], v2 offset:24576
    ds_read_b128 v[164:167], v3 offset:24576
    ds_read_b128 v[168:171], v4 offset:24576
    ds_read_b128 v[172:175], v5 offset:24576
    s_waitcnt lgkmcnt(4)
    v_mfma_f32_16x16x32_bf16 v[64:67], v[248:251], v[144:147], v[64:67]
    v_mfma_f32_4x4x4_16b_bf16 v[68:71], v[144:145], v[144:145], v[68:71]
    v_mfma_f32_4x4x4_16b_bf16 v[72:75], v[146:147], v[146:147], v[72:75]
    v_mfma_f32_16x16x32_bf16 v[64:67], v[248:251], v[152:155], v[64:67]
    v_mfma_f32_4x4x4_16b_bf16 v[68:71], v[152:153], v[152:153], v[68:71]
    v_mfma_f32_4x4x4_16b_bf16 v[72:75], v[154:155], v[154:155], v[72:75]
    s_barrier
    s_bfe_u32 s100, s70, 196624
    s_cmp_lg_u32 s100, s69
    s_cbranch_scc1 L_nxk4
    ds_read_b64 v[240:241], v16 offset:32768
    ds_read_b64 v[242:243], v17 offset:32768
    ds_read_b64 v[244:245], v18 offset:32768
    ds_read_b64 v[246:247], v19 offset:32768
L_nxk4:
    ds_read_b128 v[176:179], v2 offset:32768
    ds_read_b128 v[180:183], v3 offset:32768
    ds_read_b128 v[184:187], v4 offset:32768
    ds_read_b128 v[188:191], v5 offset:32768
    s_waitcnt lgkmcnt(4)
    v_mfma_f32_16x16x32_bf16 v[64:67], v[248:251], v[160:163], v[64:67]
    v_mfma_f32_4x4x4_16b_bf16 v[68:71], v[160:161], v[160:161], v[68:71]
    v_mfma_f32_4x4x4_16b_bf16 v[72:75], v[162:163], v[162:163], v[72:75]
    v_mfma_f32_16x16x32_bf16 v[64:67], v[248:251], v[168:171], v[64:67]
    v_mfma_f32_4x4x4_16b_bf16 v[68:71], v[168:169], v[168:169], v[68:71]
    v_mfma_f32_4x4x4_16b_bf16 v[72:75], v[170:171], v[170:171], v[72:75]
    s_barrier
    s_bfe_u32 s100, s70, 196628
    s_cmp_lg_u32 s100, s69
    s_cbranch_scc1 L_nxk5
    ds_read_b64 v[240:241], v16 offset:40960
    ds_read_b64 v[242:243], v17 offset:40960
    ds_read_b64 v[244:245], v18 offset:40960
    ds_read_b64 v[246:247], v19 offset:40960
L_nxk5:
    ds_read_b128 v[192:195], v2 offset:40960
    ds_read_b128 v[196:199], v3 offset:40960
    ds_read_b128 v[200:203], v4 offset:40960
    ds_read_b128 v[204:207], v5 offset:40960
    s_waitcnt lgkmcnt(4)
    v_mfma_f32_16x16x32_bf16 v[64:67], v[248:251], v[176:179], v[64:67]
    v_mfma_f32_4x4x4_16b_bf16 v[68:71], v[176:177], v[176:177], v[68:71]
    v_mfma_f32_4x4x4_16b_bf16 v[72:75], v[178:179], v[178:179], v[72:75]
    v_mfma_f32_16x16x32_bf16 v[64:67], v[248:251], v[184:187], v[64:67]
    v_mfma_f32_4x4x4_16b_bf16 v[68:71], v[184:185], v[184:185], v[68:71]
    v_mfma_f32_4x4x4_16b_bf16 v[72:75], v[186:187], v[186:187], v[72:75]
    s_barrier
    s_bfe_u32 s100, s70, 196632
    s_cmp_lg_u32 s100, s69
    s_cbranch_scc1 L_nxk6
    ds_read_b64 v[240:241], v16 offset:49152
    ds_read_b64 v[242:243], v17 offset:49152
    ds_read_b64 v[244:245], v18 offset:49152
    ds_read_b64 v[246:247], v19 offset:49152
L_nxk6:
    ds_read_b128 v[208:211], v2 offset:49152
    ds_read_b128 v[212:215], v3 offset:49152
    ds_read_b128 v[216:219], v4 offset:49152
    ds_read_b128 v[220:223], v5 offset:49152
    s_waitcnt lgkmcnt(4)
    v_mfma_f32_16x16x32_bf16 v[64:67], v[248:251], v[192:195], v[64:67]
    v_mfma_f32_4x4x4_16b_bf16 v[68:71], v[192:193], v[192:193], v[68:71]
    v_mfma_f32_4x4x4_16b_bf16 v[72:75], v[194:195], v[194:195], v[72:75]
    v_mfma_f32_16x16x32_bf16 v[64:67], v[248:251], v[200:203], v[64:67]
    v_mfma_f32_4x4x4_16b_bf16 v[68:71], v[200:201], v[200:201], v[68:71]
    v_mfma_f32_4x4x4_16b_bf16 v[72:75], v[202:203], v[202:203], v[72:75]
    s_barrier
    s_bfe_u32 s100, s70, 196636
    s_cmp_lg_u32 s100, s69
    s_cbranch_scc1 L_nxk7
    ds_read_b64 v[240:241], v16 offset:0
    ds_read_b64 v[242:243], v17 offset:0
    ds_read_b64 v[244:245], v18 offset:0
    ds_read_b64 v[246:247], v19 offset:0
L_nxk7:
    ds_read_b128 v[224:227], v2 offset:0
    ds_read_b128 v[228:231], v3 offset:0
    ds_read_b128 v[232:235], v4 offset:0
    ds_read_b128 v[236:239], v5 offset:0
    s_waitcnt lgkmcnt(4)
    v_mfma_f32_16x16x32_bf16 v[64:67], v[248:251], v[208:211], v[64:67]
    v_xor_b32 v3, 2048, v6
    v_xor_b32 v4, 4096, v6
    v_mfma_f32_4x4x4_16b_bf16 v[68:71], v[208:209], v[208:209], v[68:71]
    v_mfma_f32_4x4x4_16b_bf16 v[72:75], v[210:211], v[210:211], v[72:75]
    v_mfma_f32_16x16x32_bf16 v[64:67], v[248:251], v[216:219], v[64:67]
    v_xor_b32 v5, 6144, v6
    v_mfma_f32_4x4x4_16b_bf16 v[68:71], v[216:217], v[216:217], v[68:71]
    v_mfma_f32_4x4x4_16b_bf16 v[72:75], v[218:219], v[218:219], v[72:75]
    s_barrier
    ds_read_b64_tr_b16 v[16:17], v6 offset:8192
    ds_read_b64_tr_b16 v[18:19], v6 offset:8704
    ds_read_b64_tr_b16 v[20:21], v3 offset:8192
    ds_read_b64_tr_b16 v[22:23], v3 offset:8704
    ds_read_b64_tr_b16 v[24:25], v4 offset:8192
    ds_read_b64_tr_b16 v[26:27], v4 offset:8704
    ds_read_b64_tr_b16 v[28:29], v5 offset:8192
    ds_read_b64_tr_b16 v[30:31], v5 offset:8704
    s_waitcnt lgkmcnt(8)
    v_mfma_f32_16x16x32_bf16 v[64:67], v[248:251], v[224:227], v[64:67]
    v_mfma_f32_4x4x4_16b_bf16 v[68:71], v[224:225], v[224:225], v[68:71]
    v_mfma_f32_4x4x4_16b_bf16 v[72:75], v[226:227], v[226:227], v[72:75]
    v_mfma_f32_16x16x32_bf16 v[64:67], v[248:251], v[232:235], v[64:67]
    v_mfma_f32_4x4x4_16b_bf16 v[68:71], v[232:233], v[232:233], v[68:71]
    v_mfma_f32_4x4x4_16b_bf16 v[72:75], v[234:235], v[234:235], v[72:75]
    s_barrier
    s_waitcnt lgkmcnt(0)
    v_mfma_f32_16x16x32_bf16 v[252:255], v[248:251], v[16:19], 0
    ds_read_b64_tr_b16 v[32:33], v6 offset:16384
    ds_read_b64_tr_b16 v[34:35], v6 offset:16896
    v_mfma_f32_16x16x32_bf16 v[252:255], v[248:251], v[20:23], v[252:255]
    ds_read_b64_tr_b16 v[36:37], v3 offset:16384
    ds_read_b64_tr_b16 v[38:39], v3 offset:16896
    v_mfma_f32_32x32x16_bf16 v[48:63], v[16:19], v[112:115], 0
    ds_read_b64_tr_b16 v[40:41], v4 offset:16384
    ds_read_b64_tr_b16 v[42:43], v4 offset:16896
    ds_read_b64_tr_b16 v[44:45], v5 offset:16384
    ds_read_b64_tr_b16 v[46:47], v5 offset:16896
    v_add_f32 v68, v68, v72
    v_mfma_f32_32x32x16_bf16 v[48:63], v[20:23], v[116:119], v[48:63]
    v_add_f32 v69, v69, v73
    v_add_f32 v70, v70, v74
    v_add_f32 v71, v71, v75
    v_cndmask_b32_e64 v68, v68, v69, s[12:13]
    v_cndmask_b32_e64 v68, v68, v70, s[14:15]
    v_mfma_f32_32x32x16_bf16 v[48:63], v[24:27], v[120:123], v[48:63]
    v_cndmask_b32_e64 v68, v68, v71, s[16:17]
    v_mov_b32 v11, v68
    v_mov_b32 v10, v64
    v_xor_b32 v8, 1024, v14
    v_permlane32_swap_b32 v11, v68
    v_mfma_f32_32x32x16_bf16 v[48:63], v[28:31], v[124:127], v[48:63]
    v_add_f32 v11, v11, v68
    ds_write_b64 v14, v[10:11]
    s_barrier
    s_waitcnt lgkmcnt(1)
    v_mfma_f32_16x16x32_bf16 v[252:255], v[248:251], v[32:35], v[252:255]
    ds_read_b64_tr_b16 v[16:17], v6 offset:24576
    ds_read_b64_tr_b16 v[18:19], v6 offset:25088
    v_mfma_f32_16x16x32_bf16 v[252:255], v[248:251], v[36:39], v[252:255]
    ds_read_b64_tr_b16 v[20:21], v3 offset:24576
    ds_read_b64_tr_b16 v[22:23], v3 offset:25088
    v_mfma_f32_32x32x16_bf16 v[48:63], v[32:35], v[128:131], v[48:63]
    ds_read_b64_tr_b16 v[24:25], v4 offset:24576
    ds_read_b64_tr_b16 v[26:27], v4 offset:25088
    ds_read_b64_tr_b16 v[28:29], v5 offset:24576
    ds_read_b64_tr_b16 v[30:31], v5 offset:25088
    v_mfma_f32_32x32x16_bf16 v[48:63], v[36:39], v[132:135], v[48:63]
    v_mfma_f32_32x32x16_bf16 v[48:63], v[40:43], v[136:139], v[48:63]
    v_mfma_f32_32x32x16_bf16 v[48:63], v[44:47], v[140:143], v[48:63]
    s_waitcnt lgkmcnt(8)
    s_barrier
    ds_read_b64 v[8:9], v8
    s_waitcnt lgkmcnt(1)
    v_mfma_f32_16x16x32_bf16 v[252:255], v[248:251], v[16:19], v[252:255]
    ds_read_b64_tr_b16 v[32:33], v6 offset:32768
    ds_read_b64_tr_b16 v[34:35], v6 offset:33280
    v_mfma_f32_16x16x32_bf16 v[252:255], v[248:251], v[20:23], v[252:255]
    ds_read_b64_tr_b16 v[36:37], v3 offset:32768
    ds_read_b64_tr_b16 v[38:39], v3 offset:33280
    v_mfma_f32_32x32x16_bf16 v[48:63], v[16:19], v[144:147], v[48:63]
    ds_read_b64_tr_b16 v[40:41], v4 offset:32768
    ds_read_b64_tr_b16 v[42:43], v4 offset:33280
    ds_read_b64_tr_b16 v[44:45], v5 offset:32768
    ds_read_b64_tr_b16 v[46:47], v5 offset:33280
    s_add_u32 s75, s7, 122880
    v_mfma_f32_32x32x16_bf16 v[48:63], v[20:23], v[148:151], v[48:63]
    v_add_u32 v87, s75, v1
    v_add_u32 v86, s75, v7
    s_min_u32 s75, s68, 2
    s_lshl_b32 s75, s75, 1
    s_lshr_b32 s12, 0x38, s75
    v_mfma_f32_32x32x16_bf16 v[48:63], v[24:27], v[152:155], v[48:63]
    s_and_b32 s12, s12, 3
    s_mov_b32 s13, 0
    v_mfma_f32_32x32x16_bf16 v[48:63], v[28:31], v[156:159], v[48:63]
    s_barrier
    s_waitcnt lgkmcnt(0)
    v_mfma_f32_16x16x32_bf16 v[252:255], v[248:251], v[32:35], v[252:255]
    ds_read_b64_tr_b16 v[16:17], v6 offset:40960
    ds_read_b64_tr_b16 v[18:19], v6 offset:41472
    v_mfma_f32_16x16x32_bf16 v[252:255], v[248:251], v[36:39], v[252:255]
    ds_read_b64_tr_b16 v[20:21], v3 offset:40960
    ds_read_b64_tr_b16 v[22:23], v3 offset:41472
    v_mfma_f32_32x32x16_bf16 v[48:63], v[32:35], v[160:163], v[48:63]
    ds_read_b64_tr_b16 v[24:25], v4 offset:40960
    ds_read_b64_tr_b16 v[26:27], v4 offset:41472
    ds_read_b64_tr_b16 v[28:29], v5 offset:40960
    ds_read_b64_tr_b16 v[30:31], v5 offset:41472
    v_add_f32 v10, v10, v8
    v_mfma_f32_32x32x16_bf16 v[48:63], v[36:39], v[164:167], v[48:63]
    v_add_f32 v11, v11, v9
    v_mul_f32 v10, 0x3b000000, v10
    v_mul_f32 v11, 0x3b000000, v11
    v_fma_f32 v11, -v10, v10, v11
    v_max_f32 v11, 0, v11
    v_mfma_f32_32x32x16_bf16 v[48:63], v[40:43], v[168:171], v[48:63]
    v_cvt_pk_bf16_f32 v11, v11, v11
    v_lshlrev_b32 v11, 16, v11
    v_cvt_pk_bf16_f32 v10, v10, v10
    v_lshlrev_b32 v10, 16, v10
    v_mfma_f32_32x32x16_bf16 v[48:63], v[44:47], v[172:175], v[48:63]
    s_barrier
    s_waitcnt lgkmcnt(0)
    v_mfma_f32_16x16x32_bf16 v[252:255], v[248:251], v[16:19], v[252:255]
    ds_read_b64_tr_b16 v[32:33], v6 offset:49152
    ds_read_b64_tr_b16 v[34:35], v6 offset:49664
    v_mfma_f32_16x16x32_bf16 v[252:255], v[248:251], v[20:23], v[252:255]
    ds_read_b64_tr_b16 v[36:37], v3 offset:49152
    ds_read_b64_tr_b16 v[38:39], v3 offset:49664
    v_mfma_f32_32x32x16_bf16 v[48:63], v[16:19], v[176:179], v[48:63]
    ds_read_b64_tr_b16 v[40:41], v4 offset:49152
    ds_read_b64_tr_b16 v[42:43], v4 offset:49664
    ds_read_b64_tr_b16 v[44:45], v5 offset:49152
    ds_read_b64_tr_b16 v[46:47], v5 offset:49664
    v_add_f32 v11, 0x3727c5ac, v11
    v_mfma_f32_32x32x16_bf16 v[48:63], v[20:23], v[180:183], v[48:63]
    v_cvt_pk_bf16_f32 v11, v11, v11
    v_lshlrev_b32 v11, 16, v11
    v_sqrt_f32 v11, v11
    s_nop 0
    v_cvt_pk_bf16_f32 v11, v11, v11
    v_lshlrev_b32 v11, 16, v11
    v_mfma_f32_32x32x16_bf16 v[48:63], v[24:27], v[184:187], v[48:63]
    v_rcp_f32 v12, v11
    v_mul_f32 v10, -0.5, v10
    v_cvt_pk_bf16_f32 v104, v10, v10
    v_mul_f32 v13, 0x3eb8aa3b, v12
    v_mfma_f32_32x32x16_bf16 v[48:63], v[28:31], v[188:191], v[48:63]
    s_barrier
    s_waitcnt lgkmcnt(0)
    v_mfma_f32_16x16x32_bf16 v[252:255], v[248:251], v[32:35], v[252:255]
    ds_read_b64_tr_b16 v[16:17], v6 offset:0
    ds_read_b64_tr_b16 v[18:19], v6 offset:512
    v_mfma_f32_16x16x32_bf16 v[252:255], v[248:251], v[36:39], v[252:255]
    ds_read_b64_tr_b16 v[20:21], v3 offset:0
    ds_read_b64_tr_b16 v[22:23], v3 offset:512
    v_mfma_f32_32x32x16_bf16 v[48:63], v[32:35], v[192:195], v[48:63]
    ds_read_b64_tr_b16 v[24:25], v4 offset:0
    ds_read_b64_tr_b16 v[26:27], v4 offset:512
    ds_read_b64_tr_b16 v[28:29], v5 offset:0
    ds_read_b64_tr_b16 v[30:31], v5 offset:512
    s_lshl_b32 s75, s71, 7
    v_mfma_f32_32x32x16_bf16 v[48:63], v[36:39], v[196:199], v[48:63]
    s_add_u32 s75, s75, 152576
    v_and_b32 v8, 31, v0
    v_lshl_add_u32 v8, v8, 2, s75
    v_lshrrev_b32 v9, 5, v0
    v_lshl_add_u32 v9, v9, 4, s75
    v_mfma_f32_32x32x16_bf16 v[48:63], v[40:43], v[200:203], v[48:63]
    ds_write_b32 v8, v12
    v_xor_b32 v15, 512, v14
    ds_write_b32 v14, v252
    v_mfma_f32_32x32x16_bf16 v[48:63], v[44:47], v[204:207], v[48:63]
    s_barrier
    s_waitcnt lgkmcnt(2)
    v_mfma_f32_16x16x32_bf16 v[252:255], v[248:251], v[16:19], v[252:255]
    ds_read_b64_tr_b16 v[32:33], v6 offset:8192
    ds_read_b64_tr_b16 v[34:35], v6 offset:8704
    v_mfma_f32_16x16x32_bf16 v[252:255], v[248:251], v[20:23], v[252:255]
    ds_read_b64_tr_b16 v[36:37], v3 offset:8192
    ds_read_b64_tr_b16 v[38:39], v3 offset:8704
    v_mfma_f32_16x16x32_bf16 v[252:255], v[248:251], v[24:27], v[252:255]
    ds_read_b64_tr_b16 v[40:41], v4 offset:8192
    ds_read_b64_tr_b16 v[42:43], v4 offset:8704
    v_mfma_f32_16x16x32_bf16 v[252:255], v[248:251], v[28:31], v[252:255]
    ds_read_b64_tr_b16 v[44:45], v5 offset:8192
    ds_read_b64_tr_b16 v[46:47], v5 offset:8704
    v_mfma_f32_32x32x16_bf16 v[48:63], v[16:19], v[208:211], v[48:63]
    v_mfma_f32_32x32x16_bf16 v[48:63], v[20:23], v[212:215], v[48:63]
    v_mfma_f32_32x32x16_bf16 v[48:63], v[24:27], v[216:219], v[48:63]
    v_mfma_f32_32x32x16_bf16 v[48:63], v[28:31], v[220:223], v[48:63]
    s_waitcnt lgkmcnt(8)
    s_barrier
    ds_read_b32 v15, v15
    s_waitcnt lgkmcnt(1)
    v_mfma_f32_16x16x32_bf16 v[252:255], v[248:251], v[32:35], v[252:255]
    ds_read_b64_tr_b16 v[16:17], v6 offset:16384
    ds_read_b64_tr_b16 v[18:19], v6 offset:16896
    v_mfma_f32_16x16x32_bf16 v[252:255], v[248:251], v[36:39], v[252:255]
    ds_read_b64_tr_b16 v[20:21], v3 offset:16384
    ds_read_b64_tr_b16 v[22:23], v3 offset:16896
    v_mfma_f32_16x16x32_bf16 v[252:255], v[248:251], v[40:43], v[252:255]
    ds_read_b64_tr_b16 v[24:25], v4 offset:16384
    ds_read_b64_tr_b16 v[26:27], v4 offset:16896
    v_mfma_f32_16x16x32_bf16 v[252:255], v[248:251], v[44:47], v[252:255]
    ds_read_b64_tr_b16 v[28:29], v5 offset:16384
    ds_read_b64_tr_b16 v[30:31], v5 offset:16896
    v_mfma_f32_32x32x16_bf16 v[48:63], v[32:35], v[224:227], v[48:63]
    s_and_b32 s75, s71, 3
    s_lshl_b32 s18, s68, 1
    s_lshl_b32 s19, s69, 19
    s_lshl_b32 s75, s75, 11
    s_add_u32 s19, s19, s75
    v_mfma_f32_32x32x16_bf16 v[48:63], v[36:39], v[228:231], v[48:63]
    s_mov_b32 s10, 0xffff
    s_mov_b32 s11, 0xffff
    v_mfma_f32_32x32x16_bf16 v[48:63], v[40:43], v[232:235], v[48:63]
    s_waitcnt lgkmcnt(8)
    v_add_f32 v15, v15, v252
    v_cvt_pk_bf16_f32 v108, v15, v15
    v_lshlrev_b32 v108, 16, v108
    v_sub_f32 v108, v15, v108
    v_mfma_f32_32x32x16_bf16 v[48:63], v[44:47], v[236:239], v[48:63]
    v_cvt_pk_bf16_f32 v108, v15, v108
    s_nop 1
    v_mfma_f32_32x32x16_bf16 v[48:63], v[108:111], v[104:107], v[48:63]
    s_barrier
    s_waitcnt lgkmcnt(0)
    v_mfma_f32_16x16x32_bf16 v[252:255], v[248:251], v[16:19], 0
    ds_read_b64_tr_b16 v[32:33], v6 offset:24576
    ds_read_b64_tr_b16 v[34:35], v6 offset:25088
    v_mfma_f32_16x16x32_bf16 v[252:255], v[248:251], v[20:23], v[252:255]
    ds_read_b64_tr_b16 v[36:37], v3 offset:24576
    ds_read_b64_tr_b16 v[38:39], v3 offset:25088
    v_mfma_f32_32x32x16_bf16 v[64:79], v[112:115], v[16:19], 0
    ds_read_b64_tr_b16 v[40:41], v4 offset:24576
    ds_read_b64_tr_b16 v[42:43], v4 offset:25088
    ds_read_b64_tr_b16 v[44:45], v5 offset:24576
    ds_read_b64_tr_b16 v[46:47], v5 offset:25088
    v_mul_f32 v48, v48, v12
    v_mfma_f32_32x32x16_bf16 v[64:79], v[116:119], v[20:23], v[64:79]
    v_mul_f32 v49, v49, v12
    v_mul_f32 v50, v50, v12
    v_mul_f32 v51, v51, v12
    v_mul_f32 v52, v52, v12
    v_mul_f32 v53, v53, v12
    v_mfma_f32_32x32x16_bf16 v[64:79], v[120:123], v[24:27], v[64:79]
    v_mul_f32 v54, v54, v12
    v_mul_f32 v55, v55, v12
    v_cvt_pk_bf16_f32 v48, v48, v49
    v_cvt_pk_bf16_f32 v49, v50, v51
    v_cvt_pk_bf16_f32 v50, v52, v53
    v_mfma_f32_32x32x16_bf16 v[64:79], v[124:127], v[28:31], v[64:79]
    v_cvt_pk_bf16_f32 v51, v54, v55
    buffer_store_dwordx4 v[48:51], v1, s[40:43], s6 offen offset:0 sc1
    s_barrier
    s_waitcnt lgkmcnt(0)
    v_mfma_f32_16x16x32_bf16 v[252:255], v[248:251], v[32:35], v[252:255]
    ds_read_b64_tr_b16 v[16:17], v6 offset:32768
    ds_read_b64_tr_b16 v[18:19], v6 offset:33280
    v_mfma_f32_16x16x32_bf16 v[252:255], v[248:251], v[36:39], v[252:255]
    ds_read_b64_tr_b16 v[20:21], v3 offset:32768
    ds_read_b64_tr_b16 v[22:23], v3 offset:33280
    v_mfma_f32_32x32x16_bf16 v[64:79], v[128:131], v[32:35], v[64:79]
    ds_read_b64_tr_b16 v[24:25], v4 offset:32768
    ds_read_b64_tr_b16 v[26:27], v4 offset:33280
    ds_read_b64_tr_b16 v[28:29], v5 offset:32768
    ds_read_b64_tr_b16 v[30:31], v5 offset:33280
    v_mul_f32 v56, v56, v12
    v_mfma_f32_32x32x16_bf16 v[64:79], v[132:135], v[36:39], v[64:79]
    v_mul_f32 v57, v57, v12
    v_mul_f32 v58, v58, v12
    v_mul_f32 v59, v59, v12
    v_mul_f32 v60, v60, v12
    v_mul_f32 v61, v61, v12
    v_mfma_f32_32x32x16_bf16 v[64:79], v[136:139], v[40:43], v[64:79]
    v_mul_f32 v62, v62, v12
    v_mul_f32 v63, v63, v12
    v_cvt_pk_bf16_f32 v56, v56, v57
    v_cvt_pk_bf16_f32 v57, v58, v59
    v_cvt_pk_bf16_f32 v58, v60, v61
    v_mfma_f32_32x32x16_bf16 v[64:79], v[140:143], v[44:47], v[64:79]
    v_cvt_pk_bf16_f32 v59, v62, v63
    buffer_store_dwordx4 v[56:59], v1, s[40:43], s6 offen offset:2048 sc1
    s_barrier
    s_waitcnt lgkmcnt(0)
    v_mfma_f32_16x16x32_bf16 v[252:255], v[248:251], v[16:19], v[252:255]
    ds_read_b64_tr_b16 v[32:33], v6 offset:40960
    ds_read_b64_tr_b16 v[34:35], v6 offset:41472
    v_mfma_f32_16x16x32_bf16 v[252:255], v[248:251], v[20:23], v[252:255]
    ds_read_b64_tr_b16 v[36:37], v3 offset:40960
    ds_read_b64_tr_b16 v[38:39], v3 offset:41472
    v_mfma_f32_32x32x16_bf16 v[64:79], v[144:147], v[16:19], v[64:79]
    ds_read_b64_tr_b16 v[40:41], v4 offset:40960
    ds_read_b64_tr_b16 v[42:43], v4 offset:41472
    ds_read_b64_tr_b16 v[44:45], v5 offset:40960
    ds_read_b64_tr_b16 v[46:47], v5 offset:41472
    ds_read_b128 v[88:91], v9 offset:0
    v_mfma_f32_32x32x16_bf16 v[64:79], v[148:151], v[20:23], v[64:79]
    ds_read_b128 v[92:95], v9 offset:32
    ds_read_b128 v[96:99], v9 offset:64
    ds_read_b128 v[100:103], v9 offset:96
    v_mfma_f32_32x32x16_bf16 v[64:79], v[152:155], v[24:27], v[64:79]
    v_mfma_f32_32x32x16_bf16 v[64:79], v[156:159], v[28:31], v[64:79]
    s_barrier
    s_waitcnt lgkmcnt(4)
    v_mfma_f32_16x16x32_bf16 v[252:255], v[248:251], v[32:35], v[252:255]
    ds_read_b64_tr_b16 v[16:17], v6 offset:49152
    ds_read_b64_tr_b16 v[18:19], v6 offset:49664
    v_mfma_f32_16x16x32_bf16 v[252:255], v[248:251], v[36:39], v[252:255]
    ds_read_b64_tr_b16 v[20:21], v3 offset:49152
    ds_read_b64_tr_b16 v[22:23], v3 offset:49664
    v_mfma_f32_32x32x16_bf16 v[64:79], v[160:163], v[32:35], v[64:79]
    ds_read_b64_tr_b16 v[24:25], v4 offset:49152
    ds_read_b64_tr_b16 v[26:27], v4 offset:49664
    ds_read_b64_tr_b16 v[28:29], v5 offset:49152
    ds_read_b64_tr_b16 v[30:31], v5 offset:49664
    v_mov_b32 v8, 153088
    v_mfma_f32_32x32x16_bf16 v[64:79], v[164:167], v[36:39], v[64:79]
    ds_read_b64 v[8:9], v8
    s_add_i32 s75, s18, -3
    s_lshl_b32 s76, s75, 13
    s_add_u32 s76, s76, s19
    v_mfma_f32_32x32x16_bf16 v[64:79], v[168:171], v[40:43], v[64:79]
    s_cmp_ge_i32 s75, 0
    s_cselect_b32 s76, s76, 2147483648
    s_cselect_b32 s20, 0x3f803f80, 0
    s_mov_b32 s21, s20
    v_add_u32 v2, s76, v1
    v_mfma_f32_32x32x16_bf16 v[64:79], v[172:175], v[44:47], v[64:79]
    s_barrier
    s_waitcnt lgkmcnt(1)
    v_mfma_f32_16x16x32_bf16 v[252:255], v[248:251], v[16:19], v[252:255]
    ds_read_b64_tr_b16 v[32:33], v6 offset:0
    ds_read_b64_tr_b16 v[34:35], v6 offset:512
    v_mfma_f32_16x16x32_bf16 v[252:255], v[248:251], v[20:23], v[252:255]
    ds_read_b64_tr_b16 v[36:37], v3 offset:0
    ds_read_b64_tr_b16 v[38:39], v3 offset:512
    v_mfma_f32_32x32x16_bf16 v[64:79], v[176:179], v[16:19], v[64:79]
    ds_read_b64_tr_b16 v[40:41], v4 offset:0
    ds_read_b64_tr_b16 v[42:43], v4 offset:512
    ds_read_b64_tr_b16 v[44:45], v5 offset:0
    ds_read_b64_tr_b16 v[46:47], v5 offset:512
    s_add_i32 s75, s18, -2
    v_mfma_f32_32x32x16_bf16 v[64:79], v[180:183], v[20:23], v[64:79]
    s_lshl_b32 s76, s75, 13
    s_add_u32 s76, s76, s19
    s_cmp_ge_i32 s75, 0
    s_cselect_b32 s76, s76, 2147483648
    s_cselect_b32 s22, 0x3f803f80, 0
    v_mfma_f32_32x32x16_bf16 v[64:79], v[184:187], v[24:27], v[64:79]
    s_mov_b32 s23, s22
    v_add_u32 v10, s76, v1
    v_mfma_f32_32x32x16_bf16 v[64:79], v[188:191], v[28:31], v[64:79]
    s_barrier
    s_waitcnt lgkmcnt(0)
    v_mfma_f32_16x16x32_bf16 v[252:255], v[248:251], v[32:35], v[252:255]
    ds_read_b64_tr_b16 v[16:17], v6 offset:8192
    ds_read_b64_tr_b16 v[18:19], v6 offset:8704
    v_mfma_f32_16x16x32_bf16 v[252:255], v[248:251], v[36:39], v[252:255]
    ds_read_b64_tr_b16 v[20:21], v3 offset:8192
    ds_read_b64_tr_b16 v[22:23], v3 offset:8704
    v_mfma_f32_32x32x16_bf16 v[64:79], v[192:195], v[32:35], v[64:79]
    ds_read_b64_tr_b16 v[24:25], v4 offset:8192
    ds_read_b64_tr_b16 v[26:27], v4 offset:8704
    ds_read_b64_tr_b16 v[28:29], v5 offset:8192
    ds_read_b64_tr_b16 v[30:31], v5 offset:8704
    v_readfirstlane_b32 s72, v8
    v_readfirstlane_b32 s79, v9
    v_mfma_f32_32x32x16_bf16 v[64:79], v[196:199], v[36:39], v[64:79]
    v_mov_b32 v80, v8
    s_add_i32 s75, s18, -1
    s_lshl_b32 s76, s75, 13
    s_add_u32 s76, s76, s19
    s_cmp_ge_i32 s75, 0
    s_cselect_b32 s76, s76, 2147483648
    s_cselect_b32 s24, 0x3f803f80, 0
    v_mfma_f32_32x32x16_bf16 v[64:79], v[200:203], v[40:43], v[64:79]
    s_mov_b32 s25, s24
    v_add_u32 v11, s76, v1
    v_xor_b32 v15, 512, v14
    ds_write_b32 v14, v252
    ds_write_b128 v87, v[48:51] offset:0
    ds_write_b128 v87, v[56:59] offset:2048
    v_mfma_f32_32x32x16_bf16 v[64:79], v[204:207], v[44:47], v[64:79]
    s_waitcnt vmcnt(0)
    s_barrier
    s_mov_b64 exec, 1
    buffer_store_dword v80, v84, s[40:43], 0 offen sc1
    s_mov_b64 exec, -1
    s_waitcnt lgkmcnt(3)
    v_mfma_f32_16x16x32_bf16 v[252:255], v[248:251], v[16:19], v[252:255]
    ds_read_b64_tr_b16 v[32:33], v6 offset:16384
    ds_read_b64_tr_b16 v[34:35], v6 offset:16896
    v_mfma_f32_16x16x32_bf16 v[252:255], v[248:251], v[20:23], v[252:255]
    ds_read_b64_tr_b16 v[36:37], v3 offset:16384
    ds_read_b64_tr_b16 v[38:39], v3 offset:16896
    v_mfma_f32_16x16x32_bf16 v[252:255], v[248:251], v[24:27], v[252:255]
    ds_read_b64_tr_b16 v[40:41], v4 offset:16384
    ds_read_b64_tr_b16 v[42:43], v4 offset:16896
    v_mfma_f32_16x16x32_bf16 v[252:255], v[248:251], v[28:31], v[252:255]
    ds_read_b64_tr_b16 v[44:45], v5 offset:16384
    ds_read_b64_tr_b16 v[46:47], v5 offset:16896
    v_mfma_f32_32x32x16_bf16 v[64:79], v[208:211], v[16:19], v[64:79]
    v_mfma_f32_32x32x16_bf16 v[64:79], v[212:215], v[20:23], v[64:79]
    v_mfma_f32_32x32x16_bf16 v[64:79], v[216:219], v[24:27], v[64:79]
    v_mfma_f32_32x32x16_bf16 v[64:79], v[220:223], v[28:31], v[64:79]
    s_waitcnt lgkmcnt(10)
    s_barrier
    ds_read_b32 v15, v15
    s_waitcnt lgkmcnt(1)
    v_mfma_f32_16x16x32_bf16 v[252:255], v[248:251], v[32:35], v[252:255]
    ds_read_b64_tr_b16 v[16:17], v6 offset:24576
    ds_read_b64_tr_b16 v[18:19], v6 offset:25088
    v_mfma_f32_16x16x32_bf16 v[252:255], v[248:251], v[36:39], v[252:255]
    ds_read_b64_tr_b16 v[20:21], v3 offset:24576
    ds_read_b64_tr_b16 v[22:23], v3 offset:25088
    v_mfma_f32_16x16x32_bf16 v[252:255], v[248:251], v[40:43], v[252:255]
    ds_read_b64_tr_b16 v[24:25], v4 offset:24576
    ds_read_b64_tr_b16 v[26:27], v4 offset:25088
    v_mfma_f32_16x16x32_bf16 v[252:255], v[248:251], v[44:47], v[252:255]
    ds_read_b64_tr_b16 v[28:29], v5 offset:24576
    ds_read_b64_tr_b16 v[30:31], v5 offset:25088
    v_mfma_f32_32x32x16_bf16 v[64:79], v[224:227], v[32:35], v[64:79]
    s_lshl_b32 s75, s68, 7
    s_add_u32 s75, s75, 7413728
    v_lshl_add_u32 v84, v0, 2, s75
    s_mov_b64 exec, 0xff
    v_add_u32 v84, 0x8000, v83
    s_mov_b64 exec, -1
    v_mfma_f32_32x32x16_bf16 v[64:79], v[228:231], v[36:39], v[64:79]
    v_mfma_f32_32x32x16_bf16 v[64:79], v[232:235], v[40:43], v[64:79]
    s_waitcnt lgkmcnt(8)
    v_add_f32 v15, v15, v252
    v_cvt_pk_bf16_f32 v108, v15, v15
    v_lshlrev_b32 v108, 16, v108
    v_sub_f32 v108, v15, v108
    v_mfma_f32_32x32x16_bf16 v[64:79], v[236:239], v[44:47], v[64:79]
    v_cvt_pk_bf16_f32 v108, v15, v108
    s_nop 1
    v_mfma_f32_32x32x16_bf16 v[64:79], v[104:107], v[108:111], v[64:79]
    s_barrier
    s_waitcnt lgkmcnt(0)
    v_mfma_f32_16x16x32_bf16 v[252:255], v[248:251], v[16:19], 0
    ds_read_b64_tr_b16 v[32:33], v6 offset:32768
    ds_read_b64_tr_b16 v[34:35], v6 offset:33280
    v_mfma_f32_16x16x32_bf16 v[252:255], v[248:251], v[20:23], v[252:255]
    ds_read_b64_tr_b16 v[36:37], v3 offset:32768
    ds_read_b64_tr_b16 v[38:39], v3 offset:33280
    v_mfma_f32_32x32x16_bf16 v[48:63], v[16:19], v[112:115], 0
    ds_read_b64_tr_b16 v[40:41], v4 offset:32768
    ds_read_b64_tr_b16 v[42:43], v4 offset:33280
    ds_read_b64_tr_b16 v[44:45], v5 offset:32768
    ds_read_b64_tr_b16 v[46:47], v5 offset:33280
    v_mul_f32 v64, v64, v88
    v_mfma_f32_32x32x16_bf16 v[48:63], v[20:23], v[116:119], v[48:63]
    v_mul_f32 v65, v65, v89
    v_mul_f32 v66, v66, v90
    v_mul_f32 v67, v67, v91
    v_mul_f32 v68, v68, v92
    v_mul_f32 v69, v69, v93
    v_mfma_f32_32x32x16_bf16 v[48:63], v[24:27], v[120:123], v[48:63]
    v_mul_f32 v70, v70, v94
    v_mul_f32 v71, v71, v95
    v_cvt_pk_bf16_f32 v64, v64, v65
    v_cvt_pk_bf16_f32 v65, v66, v67
    v_cvt_pk_bf16_f32 v66, v68, v69
    v_mfma_f32_32x32x16_bf16 v[48:63], v[28:31], v[124:127], v[48:63]
    v_cvt_pk_bf16_f32 v67, v70, v71
    buffer_store_dwordx4 v[64:67], v7, s[40:43], s6 offen offset:1024 sc1
    s_barrier
    s_waitcnt lgkmcnt(0)
    v_mfma_f32_16x16x32_bf16 v[252:255], v[248:251], v[32:35], v[252:255]
    ds_read_b64_tr_b16 v[16:17], v6 offset:40960
    ds_read_b64_tr_b16 v[18:19], v6 offset:41472
    v_mfma_f32_16x16x32_bf16 v[252:255], v[248:251], v[36:39], v[252:255]
    ds_read_b64_tr_b16 v[20:21], v3 offset:40960
    ds_read_b64_tr_b16 v[22:23], v3 offset:41472
    v_mfma_f32_32x32x16_bf16 v[48:63], v[32:35], v[128:131], v[48:63]
    ds_read_b64_tr_b16 v[24:25], v4 offset:40960
    ds_read_b64_tr_b16 v[26:27], v4 offset:41472
    ds_read_b64_tr_b16 v[28:29], v5 offset:40960
    ds_read_b64_tr_b16 v[30:31], v5 offset:41472
    v_mul_f32 v72, v72, v96
    v_mfma_f32_32x32x16_bf16 v[48:63], v[36:39], v[132:135], v[48:63]
    v_mul_f32 v73, v73, v97
    v_mul_f32 v74, v74, v98
    v_mul_f32 v75, v75, v99
    v_mul_f32 v76, v76, v100
    v_mul_f32 v77, v77, v101
    v_mfma_f32_32x32x16_bf16 v[48:63], v[40:43], v[136:139], v[48:63]
    v_mul_f32 v78, v78, v102
    v_mul_f32 v79, v79, v103
    v_cvt_pk_bf16_f32 v72, v72, v73
    v_cvt_pk_bf16_f32 v73, v74, v75
    v_cvt_pk_bf16_f32 v74, v76, v77
    v_mfma_f32_32x32x16_bf16 v[48:63], v[44:47], v[140:143], v[48:63]
    v_cvt_pk_bf16_f32 v75, v78, v79
    buffer_store_dwordx4 v[72:75], v7, s[40:43], s6 offen offset:1280 sc1
    s_barrier
    s_waitcnt lgkmcnt(0)
    v_mfma_f32_16x16x32_bf16 v[252:255], v[248:251], v[16:19], v[252:255]
    ds_read_b64_tr_b16 v[32:33], v6 offset:49152
    ds_read_b64_tr_b16 v[34:35], v6 offset:49664
    v_mfma_f32_16x16x32_bf16 v[252:255], v[248:251], v[20:23], v[252:255]
    ds_read_b64_tr_b16 v[36:37], v3 offset:49152
    ds_read_b64_tr_b16 v[38:39], v3 offset:49664
    v_mfma_f32_32x32x16_bf16 v[48:63], v[16:19], v[144:147], v[48:63]
    ds_read_b64_tr_b16 v[40:41], v4 offset:49152
    ds_read_b64_tr_b16 v[42:43], v4 offset:49664
    ds_read_b64_tr_b16 v[44:45], v5 offset:49152
    ds_read_b64_tr_b16 v[46:47], v5 offset:49664
    s_lshr_b32 s75, s7, 1
    v_mfma_f32_32x32x16_bf16 v[48:63], v[20:23], v[148:151], v[48:63]
    s_add_u32 s75, s75, 139264
    v_add_u32 v87, s75, v1
    v_add_u32 v8, 147456, v1
    ds_read_b128 v[88:91], v8 offset:0
    ds_read_b128 v[92:95], v8 offset:1024
    v_mfma_f32_32x32x16_bf16 v[48:63], v[24:27], v[152:155], v[48:63]
    ds_read_b128 v[96:99], v8 offset:2048
    ds_read_b128 v[100:103], v8 offset:3072
    v_mfma_f32_32x32x16_bf16 v[48:63], v[28:31], v[156:159], v[48:63]
    s_barrier
    s_waitcnt lgkmcnt(4)
    v_mfma_f32_16x16x32_bf16 v[252:255], v[248:251], v[32:35], v[252:255]
    ds_read_b64_tr_b16 v[16:17], v6 offset:0
    ds_read_b64_tr_b16 v[18:19], v6 offset:512
    v_mfma_f32_16x16x32_bf16 v[252:255], v[248:251], v[36:39], v[252:255]
    ds_read_b64_tr_b16 v[20:21], v3 offset:0
    ds_read_b64_tr_b16 v[22:23], v3 offset:512
    v_mfma_f32_32x32x16_bf16 v[48:63], v[32:35], v[160:163], v[48:63]
    ds_read_b64_tr_b16 v[24:25], v4 offset:0
    ds_read_b64_tr_b16 v[26:27], v4 offset:512
    ds_read_b64_tr_b16 v[28:29], v5 offset:0
    ds_read_b64_tr_b16 v[30:31], v5 offset:512
    v_mov_b64 v[112:113], s[20:21]
    v_mfma_f32_32x32x16_bf16 v[48:63], v[36:39], v[164:167], v[48:63]
    v_mov_b64 v[114:115], s[20:21]
    v_mov_b64 v[116:117], s[20:21]
    v_mov_b64 v[118:119], s[20:21]
    v_mov_b64 v[120:121], s[22:23]
    v_mov_b64 v[122:123], s[22:23]
    v_mfma_f32_32x32x16_bf16 v[48:63], v[40:43], v[168:171], v[48:63]
    v_mov_b64 v[124:125], s[22:23]
    v_mov_b64 v[126:127], s[22:23]
    v_mov_b64 v[128:129], s[24:25]
    v_mov_b64 v[130:131], s[24:25]
    v_mov_b64 v[132:133], s[24:25]
    v_mfma_f32_32x32x16_bf16 v[48:63], v[44:47], v[172:175], v[48:63]
    v_mov_b64 v[134:135], s[24:25]
    s_barrier
    s_waitcnt lgkmcnt(0)
    v_mfma_f32_16x16x32_bf16 v[252:255], v[248:251], v[16:19], v[252:255]
    ds_read_b64_tr_b16 v[32:33], v6 offset:8192
    ds_read_b64_tr_b16 v[34:35], v6 offset:8704
    v_mfma_f32_16x16x32_bf16 v[252:255], v[248:251], v[20:23], v[252:255]
    ds_read_b64_tr_b16 v[36:37], v3 offset:8192
    ds_read_b64_tr_b16 v[38:39], v3 offset:8704
    v_mfma_f32_32x32x16_bf16 v[48:63], v[16:19], v[176:179], v[48:63]
    ds_read_b64_tr_b16 v[40:41], v4 offset:8192
    ds_read_b64_tr_b16 v[42:43], v4 offset:8704
    ds_read_b64_tr_b16 v[44:45], v5 offset:8192
    ds_read_b64_tr_b16 v[46:47], v5 offset:8704
    s_mov_b32 s14, 0x3f803f80
    s_mov_b32 s15, s14
    v_mfma_f32_32x32x16_bf16 v[48:63], v[20:23], v[180:183], v[48:63]
    v_mov_b64 v[136:137], s[14:15]
    v_mov_b64 v[138:139], s[14:15]
    v_mov_b64 v[140:141], s[14:15]
    v_mov_b64 v[142:143], s[14:15]
    v_mov_b64 v[144:145], s[14:15]
    v_mfma_f32_32x32x16_bf16 v[48:63], v[24:27], v[184:187], v[48:63]
    v_mov_b64 v[146:147], s[14:15]
    v_mov_b64 v[148:149], s[14:15]
    v_mov_b64 v[150:151], s[14:15]
    v_xor_b32 v15, 512, v14
    ds_write_b32 v14, v252
    v_mfma_f32_32x32x16_bf16 v[48:63], v[28:31], v[188:191], v[48:63]
    ds_write_b128 v86, v[64:67] offset:1024
    ds_write_b128 v86, v[72:75] offset:1280
    s_barrier
    s_mov_b64 exec, 3
    buffer_load_dword v82, v83, s[40:43], 0 offen sc1
    s_mov_b64 exec, -1
    s_waitcnt lgkmcnt(3)
    v_mfma_f32_16x16x32_bf16 v[252:255], v[248:251], v[32:35], v[252:255]
    ds_read_b64_tr_b16 v[16:17], v6 offset:16384
    ds_read_b64_tr_b16 v[18:19], v6 offset:16896
    v_mfma_f32_16x16x32_bf16 v[252:255], v[248:251], v[36:39], v[252:255]
    ds_read_b64_tr_b16 v[20:21], v3 offset:16384
    ds_read_b64_tr_b16 v[22:23], v3 offset:16896
    v_mfma_f32_16x16x32_bf16 v[252:255], v[248:251], v[40:43], v[252:255]
    ds_read_b64_tr_b16 v[24:25], v4 offset:16384
    ds_read_b64_tr_b16 v[26:27], v4 offset:16896
    v_mfma_f32_16x16x32_bf16 v[252:255], v[248:251], v[44:47], v[252:255]
    ds_read_b64_tr_b16 v[28:29], v5 offset:16384
    ds_read_b64_tr_b16 v[30:31], v5 offset:16896
    v_mfma_f32_32x32x16_bf16 v[48:63], v[32:35], v[192:195], v[48:63]
    s_lshl_b32 s75, s71, 10
    s_add_u32 s76, s75, 139264
    v_add_u32 v8, s76, v1
    s_lshl_b32 s75, s71, 11
    s_add_u32 s76, s75, 122880
    v_mfma_f32_32x32x16_bf16 v[48:63], v[36:39], v[196:199], v[48:63]
    v_add_u32 v9, s76, v1
    v_mfma_f32_32x32x16_bf16 v[48:63], v[40:43], v[200:203], v[48:63]
    v_mfma_f32_32x32x16_bf16 v[48:63], v[44:47], v[204:207], v[48:63]
    s_waitcnt lgkmcnt(10)
    s_waitcnt vmcnt(1)
    s_barrier
    ds_read_b32 v15, v15
    s_mov_b64 exec, 1
    buffer_store_dword v80, v85, s[40:43], 0 offen sc1
    s_mov_b64 exec, -1
    s_waitcnt lgkmcnt(1)
    v_mfma_f32_16x16x32_bf16 v[252:255], v[248:251], v[16:19], v[252:255]
    ds_read_b64_tr_b16 v[32:33], v6 offset:24576
    ds_read_b64_tr_b16 v[34:35], v6 offset:25088
    v_mfma_f32_16x16x32_bf16 v[252:255], v[248:251], v[20:23], v[252:255]
    ds_read_b64_tr_b16 v[36:37], v3 offset:24576
    ds_read_b64_tr_b16 v[38:39], v3 offset:25088
    v_mfma_f32_16x16x32_bf16 v[252:255], v[248:251], v[24:27], v[252:255]
    ds_read_b64_tr_b16 v[40:41], v4 offset:24576
    ds_read_b64_tr_b16 v[42:43], v4 offset:25088
    v_mfma_f32_16x16x32_bf16 v[252:255], v[248:251], v[28:31], v[252:255]
    ds_read_b64_tr_b16 v[44:45], v5 offset:24576
    ds_read_b64_tr_b16 v[46:47], v5 offset:25088
    v_mfma_f32_32x32x16_bf16 v[48:63], v[16:19], v[208:211], v[48:63]
    v_mfma_f32_32x32x16_bf16 v[48:63], v[20:23], v[212:215], v[48:63]
    v_mfma_f32_32x32x16_bf16 v[48:63], v[24:27], v[216:219], v[48:63]
    v_mfma_f32_32x32x16_bf16 v[48:63], v[28:31], v[220:223], v[48:63]
    s_waitcnt lgkmcnt(6)
    v_mfma_f32_16x16x32_bf16 v[252:255], v[248:251], v[32:35], v[252:255]
    v_mfma_f32_32x32x16_bf16 v[48:63], v[32:35], v[224:227], v[48:63]
    s_waitcnt lgkmcnt(4)
    v_mfma_f32_16x16x32_bf16 v[252:255], v[248:251], v[36:39], v[252:255]
    s_waitcnt lgkmcnt(2)
    v_mfma_f32_16x16x32_bf16 v[252:255], v[248:251], v[40:43], v[252:255]
    s_waitcnt lgkmcnt(0)
    v_mfma_f32_16x16x32_bf16 v[252:255], v[248:251], v[44:47], v[252:255]
    v_mfma_f32_32x32x16_bf16 v[48:63], v[36:39], v[228:231], v[48:63]
    v_mfma_f32_32x32x16_bf16 v[48:63], v[40:43], v[232:235], v[48:63]
    s_nop 5
    v_add_f32 v15, v15, v252
    v_cvt_pk_bf16_f32 v108, v15, v15
    v_lshlrev_b32 v108, 16, v108
    v_sub_f32 v108, v15, v108
    v_mfma_f32_32x32x16_bf16 v[48:63], v[44:47], v[236:239], v[48:63]
    v_cvt_pk_bf16_f32 v108, v15, v108
    s_nop 1
    v_mfma_f32_32x32x16_bf16 v[48:63], v[108:111], v[104:107], v[48:63]
    s_nop 11
    v_pk_mul_f32 v[48:49], v[48:49], v[12:13] op_sel:[0,1] op_sel_hi:[1,1]
    v_pk_mul_f32 v[50:51], v[50:51], v[12:13] op_sel:[0,1] op_sel_hi:[1,1]
    v_pk_mul_f32 v[52:53], v[52:53], v[12:13] op_sel:[0,1] op_sel_hi:[1,1]
    v_pk_mul_f32 v[54:55], v[54:55], v[12:13] op_sel:[0,1] op_sel_hi:[1,1]
    v_cvt_pk_bf16_f32 v48, v48, v49
    v_cvt_pk_bf16_f32 v49, v50, v51
    v_cvt_pk_bf16_f32 v50, v52, v53
    v_cvt_pk_bf16_f32 v51, v54, v55
    ds_write_b128 v87, v[48:51] offset:0
    v_pk_mul_f32 v[56:57], v[56:57], v[12:13] op_sel:[0,1] op_sel_hi:[1,1]
    v_pk_mul_f32 v[58:59], v[58:59], v[12:13] op_sel:[0,1] op_sel_hi:[1,1]
    v_pk_mul_f32 v[60:61], v[60:61], v[12:13] op_sel:[0,1] op_sel_hi:[1,1]
    v_pk_mul_f32 v[62:63], v[62:63], v[12:13] op_sel:[0,1] op_sel_hi:[1,1]
    v_cvt_pk_bf16_f32 v56, v56, v57
    v_cvt_pk_bf16_f32 v57, v58, v59
    v_cvt_pk_bf16_f32 v58, v60, v61
    v_cvt_pk_bf16_f32 v59, v62, v63
    ds_write_b128 v87, v[56:59] offset:1024
    s_waitcnt lgkmcnt(0)
    s_barrier
    ds_read_b128 v[172:175], v8
    ds_read_b128 v[164:167], v9
    ds_read_b128 v[176:179], v8 offset:4096
    ds_read_b128 v[168:171], v9 offset:8192
    s_mov_b64 exec, s[10:11]
    ds_read_b128 v[136:139], v9 offset:1024
    ds_read_b128 v[140:143], v9 offset:1280
    ds_read_b128 v[144:147], v9 offset:9216
    ds_read_b128 v[148:151], v9 offset:9472
    s_mov_b64 exec, -1

    v_bfe_u32 v3, v0, 2, 3
    v_lshlrev_b32 v3, 7, v3
    v_and_b32 v4, 32, v0
    v_lshl_add_u32 v3, v4, 6, v3
    v_and_b32 v4, 3, v0
    v_lshl_add_u32 v3, v4, 3, v3
    v_and_b32 v4, 0x18, v0
    v_lshl_add_u32 v3, v4, 2, v3
    v_add_u32 v3, 57344, v3
    s_lshl_b32 s100, s68, 16
    s_and_b32 s101, s71, 2
    s_lshl_b32 s101, s101, 14
    s_add_u32 s100, s100, s101
    s_and_b32 s101, s71, 1
    s_lshl_b32 s101, s101, 8
    s_add_u32 s100, s100, s101
    s_add_u32 s100, s100, 4194304
    v_and_b32 v7, 0x30, v0
    v_lshl_add_u32 v7, v7, 4, v1
    v_add_u32 v7, s100, v7
    v_xor_b32 v4, 32, v3
    v_xor_b32 v5, 64, v3
    v_xor_b32 v6, 0x60, v3
    s_waitcnt vmcnt(1)
    v_cmp_ne_u32 vcc, s72, v82
    s_and_b64 vcc, vcc, s[12:13]
    s_cbranch_vccz L_mkok
    s_mov_b64 exec, s[12:13]

    s_mov_b32 s76, 200000
L_mk:
    buffer_load_dword v82, v83, s[40:43], 0 offen sc1
    s_waitcnt vmcnt(0)
    v_cmp_ne_u32 vcc, s72, v82
    s_cbranch_vccz L_mkok
    s_sub_u32 s76, s76, 1
    s_cmp_lg_u32 s76, 0
    s_cbranch_scc1 L_mk
L_mkok:
    s_mov_b64 exec, -1
    buffer_load_dwordx4 v[152:155], v2, s[40:43], 0 offen sc1
    buffer_load_dwordx4 v[156:159], v10, s[40:43], 0 offen sc1
    buffer_load_dwordx4 v[160:163], v11, s[40:43], 0 offen sc1
    s_waitcnt lgkmcnt(0)
    v_mfma_f32_32x32x16_bf16 v[16:31], v[164:167], v[172:175], v[88:103]
    v_mfma_f32_32x32x16_bf16 v[32:47], v[164:167], v[176:179], 0
    s_nop 10
    v_exp_f32 v16, v16
    v_exp_f32 v17, v17
    v_exp_f32 v18, v18
    v_exp_f32 v19, v19
    s_lshl_b32 s48, s69, 12
    s_add_u32 s49, s48, 4096
    s_and_b32 s49, s49, 0x7000
    v_exp_f32 v20, v20
    v_exp_f32 v21, v21
    v_exp_f32 v22, v22
    v_exp_f32 v23, v23
    s_add_u32 s50, s48, 8192
    s_and_b32 s50, s50, 0x7000
    s_add_u32 s51, s48, 12288
    v_cvt_pk_bf16_f32 v48, v16, v17
    v_cvt_pk_bf16_f32 v49, v18, v19
    v_cvt_pk_bf16_f32 v50, v20, v21
    v_cvt_pk_bf16_f32 v51, v22, v23
    v_exp_f32 v24, v24
    v_exp_f32 v25, v25
    v_exp_f32 v26, v26
    v_exp_f32 v27, v27
    s_and_b32 s51, s51, 0x7000
    s_add_u32 s52, s48, 16384
    s_and_b32 s52, s52, 0x7000
    v_mfma_f32_32x32x16_bf16 v[180:195], v[136:139], v[48:51], 0
    v_exp_f32 v28, v28
    v_exp_f32 v29, v29
    v_exp_f32 v30, v30
    v_exp_f32 v31, v31
    s_add_u32 s53, s48, 20480
    s_and_b32 s53, s53, 0x7000
    s_add_u32 s54, s48, 24576
    v_cvt_pk_bf16_f32 v52, v24, v25
    v_cvt_pk_bf16_f32 v53, v26, v27
    v_cvt_pk_bf16_f32 v54, v28, v29
    v_cvt_pk_bf16_f32 v55, v30, v31
    v_mfma_f32_32x32x16_bf16 v[16:31], v[168:171], v[176:179], v[88:103]
    v_exp_f32 v32, v32
    v_exp_f32 v33, v33
    v_exp_f32 v34, v34
    v_exp_f32 v35, v35
    s_and_b32 s54, s54, 0x7000
    s_add_u32 s55, s48, 28672
    s_and_b32 s55, s55, 0x7000
    v_mfma_f32_32x32x16_bf16 v[180:195], v[140:143], v[52:55], v[180:195]
    v_exp_f32 v36, v36
    v_exp_f32 v37, v37
    v_exp_f32 v38, v38
    v_exp_f32 v39, v39
    s_lshl_b32 s100, s68, 8
    s_add_u32 s100, s100, 7405568
    s_lshl_b32 s101, s69, 4
    v_cvt_pk_bf16_f32 v56, v32, v33
    v_cvt_pk_bf16_f32 v57, v34, v35
    v_cvt_pk_bf16_f32 v58, v36, v37
    v_cvt_pk_bf16_f32 v59, v38, v39
    v_exp_f32 v40, v40
    v_exp_f32 v41, v41
    v_exp_f32 v42, v42
    v_exp_f32 v43, v43
    s_add_u32 s56, s100, s101
    s_lshl_b32 s101, s71, 2
    s_add_u32 s56, s56, s101
    v_mfma_f32_32x32x16_bf16 v[196:211], v[136:139], v[56:59], 0
    v_exp_f32 v44, v44
    v_exp_f32 v45, v45
    v_exp_f32 v46, v46
    v_exp_f32 v47, v47
    s_add_u32 s56, s56, 128
    s_and_b32 s101, s71, 2
    s_lshl_b32 s101, s101, 6
    v_cvt_pk_bf16_f32 v60, v40, v41
    v_cvt_pk_bf16_f32 v61, v42, v43
    v_cvt_pk_bf16_f32 v62, v44, v45
    v_cvt_pk_bf16_f32 v63, v46, v47
    s_mov_b64 exec, 0xff07
    buffer_load_dword v82, v84, s[40:43], 0 offen sc1
    s_mov_b64 exec, -1
    s_waitcnt vmcnt(3)
    v_mfma_f32_32x32x16_bf16 v[32:47], v[152:155], v[172:175], 0
    v_exp_f32 v16, v16
    v_exp_f32 v17, v17
    v_exp_f32 v18, v18
    v_exp_f32 v19, v19
    s_add_u32 s57, s100, 128
    s_lshl_b32 s100, s68, 2
    s_add_u32 s100, s100, s71
    v_mfma_f32_32x32x16_bf16 v[196:211], v[140:143], v[60:63], v[196:211]
    v_exp_f32 v20, v20
    v_exp_f32 v21, v21
    v_exp_f32 v22, v22
    v_exp_f32 v23, v23
    s_lshl_b32 s63, s100, 4
    s_lshl_b32 s59, s100, 11
    s_add_u32 s59, s59, 6291456
    v_cvt_pk_bf16_f32 v64, v16, v17
    v_cvt_pk_bf16_f32 v65, v18, v19
    v_cvt_pk_bf16_f32 v66, v20, v21
    v_cvt_pk_bf16_f32 v67, v22, v23
    v_exp_f32 v24, v24
    v_exp_f32 v25, v25
    v_exp_f32 v26, v26
    v_exp_f32 v27, v27
    s_lshl_b32 s101, s69, 8
    s_add_u32 s58, s59, s101
    s_lshl_b32 s60, s100, 12
    v_mfma_f32_32x32x16_bf16 v[196:211], v[144:147], v[64:67], v[196:211]
    v_exp_f32 v28, v28
    v_exp_f32 v29, v29
    v_exp_f32 v30, v30
    v_exp_f32 v31, v31
    s_lshl_b32 s101, s69, 9
    s_add_u32 s60, s60, s101
    s_add_u32 s60, s60, 6553600
    v_cvt_pk_bf16_f32 v68, v24, v25
    v_cvt_pk_bf16_f32 v69, v26, v27
    v_cvt_pk_bf16_f32 v70, v28, v29
    v_cvt_pk_bf16_f32 v71, v30, v31
    v_mfma_f32_32x32x16_bf16 v[16:31], v[152:155], v[176:179], 0
    v_exp_f32 v32, v32
    v_exp_f32 v33, v33
    v_exp_f32 v34, v34
    v_exp_f32 v35, v35
    s_lshl_b32 s61, s100, 3
    s_add_u32 s61, s61, s48
    s_lshl_b32 s61, s61, 4
    v_mfma_f32_32x32x16_bf16 v[196:211], v[148:151], v[68:71], v[196:211]
    v_exp_f32 v36, v36
    v_exp_f32 v37, v37
    v_exp_f32 v38, v38
    v_exp_f32 v39, v39
    s_add_u32 s61, s61, 7426048
    s_mul_i32 s101, s68, 384
    s_sub_u32 s61, s61, s101
    v_cvt_pk_bf16_f32 v72, v32, v33
    v_cvt_pk_bf16_f32 v73, v34, v35
    v_cvt_pk_bf16_f32 v74, v36, v37
    v_cvt_pk_bf16_f32 v75, v38, v39
    v_exp_f32 v40, v40
    v_exp_f32 v41, v41
    v_exp_f32 v42, v42
    v_exp_f32 v43, v43
    s_mul_i32 s101, s71, 120
    s_sub_u32 s61, s61, s101
    s_lshl_b32 s62, s100, 14
    v_exp_f32 v44, v44
    v_exp_f32 v45, v45
    v_exp_f32 v46, v46
    v_exp_f32 v47, v47
    s_lshl_b32 s101, s69, 7
    s_add_u32 s62, s62, s101
    s_add_u32 s36, s101, 151552
    v_cvt_pk_bf16_f32 v76, v40, v41
    v_cvt_pk_bf16_f32 v77, v42, v43
    v_cvt_pk_bf16_f32 v78, v44, v45
    v_cvt_pk_bf16_f32 v79, v46, v47
    s_waitcnt vmcnt(2)
    v_mfma_f32_32x32x16_bf16 v[32:47], v[156:159], v[172:175], 0
    s_waitcnt vmcnt(0)
    v_cmp_ne_u32 vcc, s72, v82
    v_cmp_eq_u32 s[14:15], s79, v82
    s_and_b64 vcc, vcc, s[12:13]
    s_cbranch_vccz L_vf1ok
    s_mov_b64 exec, s[12:13]

    s_mov_b32 s76, 200000
L_vf1:
    buffer_load_dword v82, v84, s[40:43], 0 offen sc1
    s_waitcnt vmcnt(0)
    v_cmp_ne_u32 vcc, s72, v82
    s_cbranch_vccz L_vf1ok
    s_sub_u32 s76, s76, 1
    s_cmp_lg_u32 s76, 0
    s_cbranch_scc1 L_vf1
L_vf1ok:
    s_mov_b64 exec, s[10:11]
    buffer_load_dwordx4 v[112:115], v2, s[40:43], 0 offen offset:1024 sc1
    buffer_load_dwordx4 v[116:119], v2, s[40:43], 0 offen offset:1280 sc1
    buffer_load_dwordx4 v[120:123], v10, s[40:43], 0 offen offset:1024 sc1
    buffer_load_dwordx4 v[124:127], v10, s[40:43], 0 offen offset:1280 sc1
    buffer_load_dwordx4 v[128:131], v11, s[40:43], 0 offen offset:1024 sc1
    buffer_load_dwordx4 v[132:135], v11, s[40:43], 0 offen offset:1280 sc1
    s_mov_b64 exec, -1
    s_and_b32 s14, s14, 0xff00
    s_cmp_eq_u32 s14, 65280
    s_cselect_b32 s3, 1, 0

    v_exp_f32 v16, v16
    v_exp_f32 v17, v17
    v_exp_f32 v18, v18
    v_exp_f32 v19, v19
    s_mov_b32 s28, 0xaaaaaaaa
    s_mov_b32 s29, 0xaaaaaaaa
    s_mov_b32 s30, 0xcccccccc
    v_exp_f32 v20, v20
    v_exp_f32 v21, v21
    v_exp_f32 v22, v22
    v_exp_f32 v23, v23
    s_mov_b32 s31, 0xcccccccc
    s_mov_b32 s32, 0x00f0000f
    s_mov_b32 s33, 0xf0000f00
    v_cvt_pk_bf16_f32 v212, v16, v17
    v_cvt_pk_bf16_f32 v213, v18, v19
    v_cvt_pk_bf16_f32 v214, v20, v21
    v_cvt_pk_bf16_f32 v215, v22, v23
    v_exp_f32 v24, v24
    v_exp_f32 v25, v25
    v_exp_f32 v26, v26
    v_exp_f32 v27, v27
    s_mov_b32 s38, 0x11111111
    s_mov_b32 s39, 0x11111111
    s_mov_b32 s16, 0x3f803f80
    v_exp_f32 v28, v28
    v_exp_f32 v29, v29
    v_exp_f32 v30, v30
    v_exp_f32 v31, v31
    s_mov_b32 s17, 0x3f803f80
    v_cvt_pk_bf16_f32 v216, v24, v25
    v_cvt_pk_bf16_f32 v217, v26, v27
    v_cvt_pk_bf16_f32 v218, v28, v29
    v_cvt_pk_bf16_f32 v219, v30, v31
    v_mfma_f32_32x32x16_bf16 v[16:31], v[156:159], v[176:179], 0
    v_exp_f32 v32, v32
    v_exp_f32 v33, v33
    v_exp_f32 v34, v34
    v_exp_f32 v35, v35
    v_exp_f32 v36, v36
    v_exp_f32 v37, v37
    v_exp_f32 v38, v38
    v_exp_f32 v39, v39
    v_cvt_pk_bf16_f32 v220, v32, v33
    v_cvt_pk_bf16_f32 v221, v34, v35
    v_cvt_pk_bf16_f32 v222, v36, v37
    v_cvt_pk_bf16_f32 v223, v38, v39
    v_exp_f32 v40, v40
    v_exp_f32 v41, v41
    v_exp_f32 v42, v42
    v_exp_f32 v43, v43
    v_exp_f32 v44, v44
    v_exp_f32 v45, v45
    v_exp_f32 v46, v46
    v_exp_f32 v47, v47
    v_cvt_pk_bf16_f32 v224, v40, v41
    v_cvt_pk_bf16_f32 v225, v42, v43
    v_cvt_pk_bf16_f32 v226, v44, v45
    v_cvt_pk_bf16_f32 v227, v46, v47
    v_mfma_f32_32x32x16_bf16 v[32:47], v[160:163], v[172:175], 0
    v_exp_f32 v16, v16
    v_exp_f32 v17, v17
    v_exp_f32 v18, v18
    v_exp_f32 v19, v19
    s_waitcnt vmcnt(5)
    v_mfma_f32_32x32x16_bf16 v[180:195], v[112:115], v[72:75], v[180:195]
    v_exp_f32 v20, v20
    v_exp_f32 v21, v21
    v_exp_f32 v22, v22
    v_exp_f32 v23, v23
    s_waitcnt vmcnt(4)
    v_mfma_f32_32x32x16_bf16 v[180:195], v[116:119], v[76:79], v[180:195]
    v_cvt_pk_bf16_f32 v228, v16, v17
    v_cvt_pk_bf16_f32 v229, v18, v19
    v_cvt_pk_bf16_f32 v230, v20, v21
    v_cvt_pk_bf16_f32 v231, v22, v23
    v_exp_f32 v24, v24
    v_exp_f32 v25, v25
    v_exp_f32 v26, v26
    v_exp_f32 v27, v27
    v_mfma_f32_32x32x16_bf16 v[196:211], v[112:115], v[212:215], v[196:211]
    v_exp_f32 v28, v28
    v_exp_f32 v29, v29
    v_exp_f32 v30, v30
    v_exp_f32 v31, v31
    v_mfma_f32_32x32x16_bf16 v[196:211], v[116:119], v[216:219], v[196:211]
    v_cvt_pk_bf16_f32 v232, v24, v25
    v_cvt_pk_bf16_f32 v233, v26, v27
    v_cvt_pk_bf16_f32 v234, v28, v29
    v_cvt_pk_bf16_f32 v235, v30, v31
    v_mfma_f32_32x32x16_bf16 v[16:31], v[160:163], v[176:179], 0
    v_exp_f32 v32, v32
    v_exp_f32 v33, v33
    v_exp_f32 v34, v34
    v_exp_f32 v35, v35
    s_waitcnt vmcnt(3)
    v_mfma_f32_32x32x16_bf16 v[180:195], v[120:123], v[220:223], v[180:195]
    v_exp_f32 v36, v36
    v_exp_f32 v37, v37
    v_exp_f32 v38, v38
    v_exp_f32 v39, v39
    s_waitcnt vmcnt(2)
    v_mfma_f32_32x32x16_bf16 v[180:195], v[124:127], v[224:227], v[180:195]
    v_cvt_pk_bf16_f32 v48, v32, v33
    v_cvt_pk_bf16_f32 v49, v34, v35
    v_cvt_pk_bf16_f32 v50, v36, v37
    v_cvt_pk_bf16_f32 v51, v38, v39
    v_exp_f32 v40, v40
    v_exp_f32 v41, v41
    v_exp_f32 v42, v42
    v_exp_f32 v43, v43
    v_mfma_f32_32x32x16_bf16 v[196:211], v[120:123], v[228:231], v[196:211]
    v_exp_f32 v44, v44
    v_exp_f32 v45, v45
    v_exp_f32 v46, v46
    v_exp_f32 v47, v47
    v_mfma_f32_32x32x16_bf16 v[196:211], v[124:127], v[232:235], v[196:211]
    v_cvt_pk_bf16_f32 v52, v40, v41
    v_cvt_pk_bf16_f32 v53, v42, v43
    v_cvt_pk_bf16_f32 v54, v44, v45
    v_cvt_pk_bf16_f32 v55, v46, v47
    v_exp_f32 v16, v16
    v_exp_f32 v17, v17
    v_exp_f32 v18, v18
    v_exp_f32 v19, v19
    s_waitcnt vmcnt(1)
    v_mfma_f32_32x32x16_bf16 v[180:195], v[128:131], v[48:51], v[180:195]
    v_exp_f32 v20, v20
    v_exp_f32 v21, v21
    v_exp_f32 v22, v22
    v_exp_f32 v23, v23
    s_waitcnt vmcnt(0)
    v_mfma_f32_32x32x16_bf16 v[180:195], v[132:135], v[52:55], v[180:195]
    v_cvt_pk_bf16_f32 v56, v16, v17
    v_cvt_pk_bf16_f32 v57, v18, v19
    v_cvt_pk_bf16_f32 v58, v20, v21
    v_cvt_pk_bf16_f32 v59, v22, v23
    v_exp_f32 v24, v24
    v_exp_f32 v25, v25
    v_exp_f32 v26, v26
    v_exp_f32 v27, v27
    v_mfma_f32_32x32x16_bf16 v[196:211], v[128:131], v[56:59], v[196:211]
    v_exp_f32 v28, v28
    v_exp_f32 v29, v29
    v_exp_f32 v30, v30
    v_exp_f32 v31, v31
    v_cvt_pk_bf16_f32 v60, v24, v25
    v_cvt_pk_bf16_f32 v61, v26, v27
    v_cvt_pk_bf16_f32 v62, v28, v29
    v_cvt_pk_bf16_f32 v63, v30, v31
    s_nop 1
    v_mfma_f32_32x32x16_bf16 v[196:211], v[132:135], v[60:63], v[196:211]
    s_and_b32 s9, s71, 3
    s_mul_i32 s7, s9, 4608
    v_add_u32 v8, s7, v1
    v_lshl_add_u32 v9, v0, 2, s7

    s_lshl_b32 s8, s68, 16
    s_lshl_b32 s7, s69, 12
    s_add_u32 s8, s8, s7
    s_lshl_b32 s9, s9, 10
    s_add_u32 s8, s8, s9
    s_add_u32 s8, s8, 4194304
    s_add_u32 s9, s8, 32768
    s_mov_b32 s14, 0x1f800000
    s_mov_b32 s15, 0x5f800000

    s_barrier
    ds_read_b32 v24, v9 offset:2048
    ds_read_b32 v40, v9 offset:4352
    ds_read_b128 v[16:19], v8 offset:0
    ds_read_b128 v[20:23], v8 offset:1024
    ds_read_b128 v[32:35], v8 offset:2304
    ds_read_b128 v[36:39], v8 offset:3328
    s_waitcnt lgkmcnt(4)
    v_add_f32 v188, v188, v24
    v_add_f32 v204, v204, v40
    v_rcp_f32 v190, v188
    v_rcp_f32 v206, v204
    v_cmp_le_f32 vcc, s14, v188
    v_cmp_ge_f32 s[12:13], s15, v188
    v_cmp_le_f32 s[4:5], s14, v204
    v_cmp_ge_f32 s[6:7], s15, v204
    s_waitcnt lgkmcnt(2)

    v_pk_add_f32 v[180:181], v[180:181], v[16:17]
    v_pk_add_f32 v[182:183], v[182:183], v[18:19]
    v_pk_add_f32 v[184:185], v[184:185], v[20:21]
    v_pk_add_f32 v[186:187], v[186:187], v[22:23]
    s_and_b64 vcc, vcc, s[12:13]
    s_cmp_eq_u64 vcc, -1
    s_cbranch_scc0 L_slow0
L_back0:

    v_pk_mul_f32 v[180:181], v[180:181], v[190:191] op_sel_hi:[1,0]
    v_pk_mul_f32 v[182:183], v[182:183], v[190:191] op_sel_hi:[1,0]
    v_pk_mul_f32 v[184:185], v[184:185], v[190:191] op_sel_hi:[1,0]
    v_pk_mul_f32 v[186:187], v[186:187], v[190:191] op_sel_hi:[1,0]
    v_cvt_pk_bf16_f32 v180, v180, v181
    v_cvt_pk_bf16_f32 v181, v182, v183
    v_cvt_pk_bf16_f32 v182, v184, v185
    v_cvt_pk_bf16_f32 v183, v186, v187
    s_waitcnt lgkmcnt(0)
    s_cmp_lg_u32 s3, 0
    s_cbranch_scc1 L_ds_1p
    buffer_store_dwordx4 v[180:183], v1, s[40:43], s8 offen sc1
    s_branch L_ds_1q
L_ds_1p:
    buffer_store_dwordx4 v[180:183], v1, s[40:43], s8 offen
L_ds_1q:
    v_pk_add_f32 v[196:197], v[196:197], v[32:33]
    v_pk_add_f32 v[198:199], v[198:199], v[34:35]
    v_pk_add_f32 v[200:201], v[200:201], v[36:37]
    v_pk_add_f32 v[202:203], v[202:203], v[38:39]
    s_and_b64 vcc, s[4:5], s[6:7]
    s_cmp_eq_u64 vcc, -1
    s_cbranch_scc0 L_slow1
L_back1:

    v_pk_mul_f32 v[196:197], v[196:197], v[206:207] op_sel_hi:[1,0]
    v_pk_mul_f32 v[198:199], v[198:199], v[206:207] op_sel_hi:[1,0]
    v_pk_mul_f32 v[200:201], v[200:201], v[206:207] op_sel_hi:[1,0]
    v_pk_mul_f32 v[202:203], v[202:203], v[206:207] op_sel_hi:[1,0]
    v_cvt_pk_bf16_f32 v196, v196, v197
    v_cvt_pk_bf16_f32 v197, v198, v199
    v_cvt_pk_bf16_f32 v198, v200, v201
    v_cvt_pk_bf16_f32 v199, v202, v203
    s_cmp_lg_u32 s3, 0
    s_cbranch_scc1 L_ds_2p
    buffer_store_dwordx4 v[196:199], v1, s[40:43], s9 offen sc1
    s_branch L_ds_2q
L_ds_2p:
    buffer_store_dwordx4 v[196:199], v1, s[40:43], s9 offen
L_ds_2q:
    ds_read_b64_tr_b16 v[96:97], v3 offset:0
    v_and_b32 v8, 31, v0
    ds_read_b64_tr_b16 v[98:99], v3 offset:1024
    ds_read_b64_tr_b16 v[100:101], v4 offset:0
    ds_read_b64_tr_b16 v[102:103], v4 offset:1024
    ds_read_b64_tr_b16 v[104:105], v5 offset:0
    ds_read_b64_tr_b16 v[106:107], v5 offset:1024
    ds_read_b64_tr_b16 v[108:109], v6 offset:0
    ds_read_b64_tr_b16 v[110:111], v6 offset:1024
    ds_read_b64_tr_b16 v[112:113], v3 offset:4096
    v_lshlrev_b32 v8, 2, v8
    ds_read_b64_tr_b16 v[114:115], v3 offset:5120
    ds_read_b64_tr_b16 v[116:117], v4 offset:4096
    ds_read_b64_tr_b16 v[118:119], v4 offset:5120
    ds_read_b64_tr_b16 v[120:121], v5 offset:4096
    ds_read_b64_tr_b16 v[122:123], v5 offset:5120
    ds_read_b64_tr_b16 v[124:125], v6 offset:4096
    ds_read_b64_tr_b16 v[126:127], v6 offset:5120
    ds_read_b64_tr_b16 v[128:129], v3 offset:8192
    v_and_b32 v10, 0x30, v0
    ds_read_b64_tr_b16 v[130:131], v3 offset:9216
    ds_read_b64_tr_b16 v[132:133], v4 offset:8192
    ds_read_b64_tr_b16 v[134:135], v4 offset:9216
    ds_read_b64_tr_b16 v[136:137], v5 offset:8192
    ds_read_b64_tr_b16 v[138:139], v5 offset:9216
    ds_read_b64_tr_b16 v[140:141], v6 offset:8192
    ds_read_b64_tr_b16 v[142:143], v6 offset:9216
    ds_read_b64_tr_b16 v[144:145], v3 offset:12288
    v_lshrrev_b32 v11, 1, v10
    ds_read_b64_tr_b16 v[146:147], v3 offset:13312
    ds_read_b64_tr_b16 v[148:149], v4 offset:12288
    ds_read_b64_tr_b16 v[150:151], v4 offset:13312
    ds_read_b64_tr_b16 v[152:153], v5 offset:12288
    ds_read_b64_tr_b16 v[154:155], v5 offset:13312
    ds_read_b64_tr_b16 v[156:157], v6 offset:12288
    ds_read_b64_tr_b16 v[158:159], v6 offset:13312
    ds_read_b64_tr_b16 v[160:161], v3 offset:16384
    v_add_u32 v11, s36, v11
    ds_read_b64_tr_b16 v[162:163], v3 offset:17408
    ds_read_b64_tr_b16 v[164:165], v4 offset:16384
    ds_read_b64_tr_b16 v[166:167], v4 offset:17408
    ds_read_b64_tr_b16 v[168:169], v5 offset:16384
    ds_read_b64_tr_b16 v[170:171], v5 offset:17408
    ds_read_b64_tr_b16 v[172:173], v6 offset:16384
    ds_read_b64_tr_b16 v[174:175], v6 offset:17408
    s_waitcnt vmcnt(0)
    s_mov_b64 exec, 1
    s_cmp_lg_u32 s3, 0
    s_cbranch_scc1 L_ds_3p
    buffer_store_dword v80, v1, s[40:43], s56 offen sc1
    s_branch L_ds_3q
L_ds_3p:
    buffer_store_dword v80, v1, s[40:43], s56 offen
L_ds_3q:
    s_mov_b64 exec, -1
    buffer_load_dword v14, v8, s[40:43], s57 offen sc1
    ds_read_b64 v[248:249], v11 offset:0
    ds_read_b64 v[250:251], v11 offset:32
    ds_read_b64 v[252:253], v11 offset:64
    ds_read_b64 v[254:255], v11 offset:96
    ds_read_b64_tr_b16 v[176:177], v3 offset:20480
    v_lshlrev_b32 v16, 16, v240
    ds_read_b64_tr_b16 v[178:179], v3 offset:21504
    v_and_b32 v17, 0xffff0000, v240
    ds_read_b64_tr_b16 v[180:181], v4 offset:20480
    v_lshlrev_b32 v18, 16, v241
    ds_read_b64_tr_b16 v[182:183], v4 offset:21504
    ds_read_b64_tr_b16 v[184:185], v5 offset:20480
    v_and_b32 v19, 0xffff0000, v241
    ds_read_b64_tr_b16 v[186:187], v5 offset:21504
    v_lshlrev_b32 v20, 16, v242
    ds_read_b64_tr_b16 v[188:189], v6 offset:20480
    ds_read_b64_tr_b16 v[190:191], v6 offset:21504
    v_and_b32 v21, 0xffff0000, v242
    ds_read_b64_tr_b16 v[192:193], v3 offset:24576
    v_lshlrev_b32 v22, 16, v243
    ds_read_b64_tr_b16 v[194:195], v3 offset:25600
    ds_read_b64_tr_b16 v[196:197], v4 offset:24576
    v_and_b32 v23, 0xffff0000, v243
    ds_read_b64_tr_b16 v[198:199], v4 offset:25600
    v_lshlrev_b32 v24, 16, v244
    ds_read_b64_tr_b16 v[200:201], v5 offset:24576
    ds_read_b64_tr_b16 v[202:203], v5 offset:25600
    v_and_b32 v25, 0xffff0000, v244
    ds_read_b64_tr_b16 v[204:205], v6 offset:24576
    v_lshlrev_b32 v26, 16, v245
    ds_read_b64_tr_b16 v[206:207], v6 offset:25600
    ds_read_b64_tr_b16 v[208:209], v3 offset:28672
    v_and_b32 v27, 0xffff0000, v245
    ds_read_b64_tr_b16 v[210:211], v3 offset:29696
    v_lshlrev_b32 v28, 16, v246
    ds_read_b64_tr_b16 v[212:213], v4 offset:28672
    v_and_b32 v29, 0xffff0000, v246
    ds_read_b64_tr_b16 v[214:215], v4 offset:29696
    ds_read_b64_tr_b16 v[216:217], v5 offset:28672
    v_lshlrev_b32 v30, 16, v247
    ds_read_b64_tr_b16 v[218:219], v5 offset:29696
    v_and_b32 v31, 0xffff0000, v247
    ds_read_b64_tr_b16 v[220:221], v6 offset:28672
    ds_read_b64_tr_b16 v[222:223], v6 offset:29696
    v_and_b32 v9, 0xff, v1
    ds_read_b64_tr_b16 v[224:225], v3 offset:32768
    v_lshlrev_b32 v10, 2, v10
    ds_read_b64_tr_b16 v[226:227], v3 offset:33792
    ds_read_b64_tr_b16 v[228:229], v4 offset:32768
    v_lshlrev_b32 v11, 8, v10
    ds_read_b64_tr_b16 v[230:231], v4 offset:33792
    v_and_b32 v13, 15, v0
    ds_read_b64_tr_b16 v[232:233], v5 offset:32768
    ds_read_b64_tr_b16 v[234:235], v5 offset:33792
    v_add_u32 v12, s63, v13
    ds_read_b64_tr_b16 v[236:237], v6 offset:32768
    v_mov_b32 v15, 153664
    ds_read_b64_tr_b16 v[238:239], v6 offset:33792
    s_waitcnt lgkmcnt(15)
    s_mov_b64 exec, s[38:39]
    v_mov_b64 v[248:249], s[16:17]
    v_mov_b64 v[250:251], s[16:17]
    v_mov_b64 v[252:253], s[16:17]
    v_mov_b64 v[254:255], s[16:17]
    s_mov_b64 exec, -1
    s_mov_b32 s76, 200000
L_of:
    s_waitcnt vmcnt(0)
    v_cmp_ne_u32 vcc, s72, v14
    s_cbranch_vccz L_ofok
    buffer_load_dword v14, v8, s[40:43], s57 offen sc1
    s_sub_u32 s76, s76, 1
    s_cmp_lg_u32 s76, 0
    s_cbranch_scc1 L_of
L_ofok:

    buffer_load_dwordx4 v[32:35], v7, s[40:43], s48 offen offset:0 sc1
    buffer_load_dwordx4 v[36:39], v7, s[40:43], s48 offen offset:2048 sc1
    buffer_load_dwordx4 v[40:43], v7, s[40:43], s49 offen offset:0 sc1
    buffer_load_dwordx4 v[44:47], v7, s[40:43], s49 offen offset:2048 sc1
    buffer_load_dwordx4 v[48:51], v7, s[40:43], s50 offen offset:0 sc1
    buffer_load_dwordx4 v[52:55], v7, s[40:43], s50 offen offset:2048 sc1
    buffer_load_dwordx4 v[56:59], v7, s[40:43], s51 offen offset:0 sc1
    buffer_load_dwordx4 v[60:63], v7, s[40:43], s51 offen offset:2048 sc1
    s_waitcnt vmcnt(7)
    v_mfma_f32_16x16x32_bf16 v[16:19], v[96:99], v[32:35], v[16:19]
    buffer_load_dwordx4 v[64:67], v7, s[40:43], s52 offen offset:0 sc1
    v_mfma_f32_16x16x32_bf16 v[20:23], v[100:103], v[32:35], v[20:23]
    v_mfma_f32_16x16x32_bf16 v[24:27], v[104:107], v[32:35], v[24:27]
    v_mfma_f32_16x16x32_bf16 v[28:31], v[108:111], v[32:35], v[28:31]
    s_waitcnt vmcnt(7)
    v_mfma_f32_16x16x32_bf16 v[16:19], v[112:115], v[36:39], v[16:19]
    buffer_load_dwordx4 v[68:71], v7, s[40:43], s52 offen offset:2048 sc1
    ds_read_b64_tr_b16 v[96:97], v3 offset:36864
    ds_read_b64_tr_b16 v[98:99], v3 offset:37888
    v_mfma_f32_16x16x32_bf16 v[20:23], v[116:119], v[36:39], v[20:23]
    ds_read_b64_tr_b16 v[100:101], v4 offset:36864
    ds_read_b64_tr_b16 v[102:103], v4 offset:37888
    v_mfma_f32_16x16x32_bf16 v[24:27], v[120:123], v[36:39], v[24:27]
    ds_read_b64_tr_b16 v[104:105], v5 offset:36864
    ds_read_b64_tr_b16 v[106:107], v5 offset:37888
    v_mfma_f32_16x16x32_bf16 v[28:31], v[124:127], v[36:39], v[28:31]
    ds_read_b64_tr_b16 v[108:109], v6 offset:36864
    ds_read_b64_tr_b16 v[110:111], v6 offset:37888
    s_waitcnt vmcnt(7)
    v_mfma_f32_16x16x32_bf16 v[16:19], v[128:131], v[40:43], v[16:19]
    buffer_load_dwordx4 v[72:75], v7, s[40:43], s53 offen offset:0 sc1
    ds_read_b64_tr_b16 v[112:113], v3 offset:40960
    ds_read_b64_tr_b16 v[114:115], v3 offset:41984
    v_mfma_f32_16x16x32_bf16 v[20:23], v[132:135], v[40:43], v[20:23]
    ds_read_b64_tr_b16 v[116:117], v4 offset:40960
    ds_read_b64_tr_b16 v[118:119], v4 offset:41984
    v_mfma_f32_16x16x32_bf16 v[24:27], v[136:139], v[40:43], v[24:27]
    ds_read_b64_tr_b16 v[120:121], v5 offset:40960
    ds_read_b64_tr_b16 v[122:123], v5 offset:41984
    v_mfma_f32_16x16x32_bf16 v[28:31], v[140:143], v[40:43], v[28:31]
    ds_read_b64_tr_b16 v[124:125], v6 offset:40960
    ds_read_b64_tr_b16 v[126:127], v6 offset:41984
    s_waitcnt vmcnt(7)
    v_mfma_f32_16x16x32_bf16 v[16:19], v[144:147], v[44:47], v[16:19]
    buffer_load_dwordx4 v[76:79], v7, s[40:43], s53 offen offset:2048 sc1
    ds_read_b64_tr_b16 v[128:129], v3 offset:45056
    ds_read_b64_tr_b16 v[130:131], v3 offset:46080
    v_mfma_f32_16x16x32_bf16 v[20:23], v[148:151], v[44:47], v[20:23]
    ds_read_b64_tr_b16 v[132:133], v4 offset:45056
    ds_read_b64_tr_b16 v[134:135], v4 offset:46080
    v_mfma_f32_16x16x32_bf16 v[24:27], v[152:155], v[44:47], v[24:27]
    ds_read_b64_tr_b16 v[136:137], v5 offset:45056
    ds_read_b64_tr_b16 v[138:139], v5 offset:46080
    v_mfma_f32_16x16x32_bf16 v[28:31], v[156:159], v[44:47], v[28:31]
    ds_read_b64_tr_b16 v[140:141], v6 offset:45056
    ds_read_b64_tr_b16 v[142:143], v6 offset:46080
    s_waitcnt vmcnt(7)
    v_mfma_f32_16x16x32_bf16 v[16:19], v[160:163], v[48:51], v[16:19]
    buffer_load_dwordx4 v[80:83], v7, s[40:43], s54 offen offset:0 sc1
    ds_read_b64_tr_b16 v[144:145], v3 offset:49152
    ds_read_b64_tr_b16 v[146:147], v3 offset:50176
    v_mfma_f32_16x16x32_bf16 v[20:23], v[164:167], v[48:51], v[20:23]
    ds_read_b64_tr_b16 v[148:149], v4 offset:49152
    ds_read_b64_tr_b16 v[150:151], v4 offset:50176
    v_mfma_f32_16x16x32_bf16 v[24:27], v[168:171], v[48:51], v[24:27]
    ds_read_b64_tr_b16 v[152:153], v5 offset:49152
    ds_read_b64_tr_b16 v[154:155], v5 offset:50176
    v_mfma_f32_16x16x32_bf16 v[28:31], v[172:175], v[48:51], v[28:31]
    ds_read_b64_tr_b16 v[156:157], v6 offset:49152
    ds_read_b64_tr_b16 v[158:159], v6 offset:50176
    s_waitcnt vmcnt(7)
    v_mfma_f32_16x16x32_bf16 v[16:19], v[176:179], v[52:55], v[16:19]
    buffer_load_dwordx4 v[84:87], v7, s[40:43], s54 offen offset:2048 sc1
    ds_read_b64_tr_b16 v[160:161], v3 offset:53248
    ds_read_b64_tr_b16 v[162:163], v3 offset:54272
    v_mfma_f32_16x16x32_bf16 v[20:23], v[180:183], v[52:55], v[20:23]
    ds_read_b64_tr_b16 v[164:165], v4 offset:53248
    ds_read_b64_tr_b16 v[166:167], v4 offset:54272
    v_mfma_f32_16x16x32_bf16 v[24:27], v[184:187], v[52:55], v[24:27]
    ds_read_b64_tr_b16 v[168:169], v5 offset:53248
    ds_read_b64_tr_b16 v[170:171], v5 offset:54272
    v_mfma_f32_16x16x32_bf16 v[28:31], v[188:191], v[52:55], v[28:31]
    ds_read_b64_tr_b16 v[172:173], v6 offset:53248
    ds_read_b64_tr_b16 v[174:175], v6 offset:54272
    s_waitcnt vmcnt(7)
    v_mfma_f32_16x16x32_bf16 v[16:19], v[192:195], v[56:59], v[16:19]
    buffer_load_dwordx4 v[88:91], v7, s[40:43], s55 offen offset:0 sc1
    ds_read_b64_tr_b16 v[176:177], v3 offset:57344
    ds_read_b64_tr_b16 v[178:179], v3 offset:58368
    v_mfma_f32_16x16x32_bf16 v[20:23], v[196:199], v[56:59], v[20:23]
    ds_read_b64_tr_b16 v[180:181], v4 offset:57344
    ds_read_b64_tr_b16 v[182:183], v4 offset:58368
    v_mfma_f32_16x16x32_bf16 v[24:27], v[200:203], v[56:59], v[24:27]
    ds_read_b64_tr_b16 v[184:185], v5 offset:57344
    ds_read_b64_tr_b16 v[186:187], v5 offset:58368
    v_mfma_f32_16x16x32_bf16 v[28:31], v[204:207], v[56:59], v[28:31]
    ds_read_b64_tr_b16 v[188:189], v6 offset:57344
    ds_read_b64_tr_b16 v[190:191], v6 offset:58368
    s_waitcnt vmcnt(7)
    s_waitcnt lgkmcnt(15)
    v_mfma_f32_16x16x32_bf16 v[16:19], v[208:211], v[60:63], v[16:19]
    buffer_load_dwordx4 v[92:95], v7, s[40:43], s55 offen offset:2048 sc1
    s_barrier
    ds_read_b64_tr_b16 v[192:193], v3 offset:61440
    v_mfma_f32_16x16x32_bf16 v[20:23], v[212:215], v[60:63], v[20:23]
    ds_read_b64_tr_b16 v[194:195], v3 offset:62464
    ds_read_b64_tr_b16 v[196:197], v4 offset:61440
    ds_read_b64_tr_b16 v[198:199], v4 offset:62464
    v_mfma_f32_16x16x32_bf16 v[24:27], v[216:219], v[60:63], v[24:27]
    ds_read_b64_tr_b16 v[200:201], v5 offset:61440
    ds_read_b64_tr_b16 v[202:203], v5 offset:62464
    v_mfma_f32_16x16x32_bf16 v[28:31], v[220:223], v[60:63], v[28:31]
    ds_read_b64_tr_b16 v[204:205], v6 offset:61440
    ds_read_b64_tr_b16 v[206:207], v6 offset:62464
    s_waitcnt vmcnt(7)
    v_mfma_f32_16x16x32_bf16 v[16:19], v[224:227], v[64:67], v[16:19]
    ds_read_b32 v15, v15
    v_mfma_f32_16x16x32_bf16 v[20:23], v[228:231], v[64:67], v[20:23]
    v_mfma_f32_16x16x32_bf16 v[24:27], v[232:235], v[64:67], v[24:27]
    v_mfma_f32_16x16x32_bf16 v[28:31], v[236:239], v[64:67], v[28:31]
    s_waitcnt vmcnt(6)
    v_mfma_f32_16x16x32_bf16 v[16:19], v[96:99], v[68:71], v[16:19]
    v_mfma_f32_16x16x32_bf16 v[20:23], v[100:103], v[68:71], v[20:23]
    v_mfma_f32_16x16x32_bf16 v[24:27], v[104:107], v[68:71], v[24:27]
    v_mfma_f32_16x16x32_bf16 v[28:31], v[108:111], v[68:71], v[28:31]
    s_waitcnt vmcnt(5)
    v_mfma_f32_16x16x32_bf16 v[16:19], v[112:115], v[72:75], v[16:19]
    v_mfma_f32_16x16x32_bf16 v[20:23], v[116:119], v[72:75], v[20:23]
    v_mfma_f32_16x16x32_bf16 v[24:27], v[120:123], v[72:75], v[24:27]
    v_mfma_f32_16x16x32_bf16 v[28:31], v[124:127], v[72:75], v[28:31]
    s_waitcnt vmcnt(4)
    v_mfma_f32_16x16x32_bf16 v[16:19], v[128:131], v[76:79], v[16:19]
    v_mfma_f32_16x16x32_bf16 v[20:23], v[132:135], v[76:79], v[20:23]
    v_mfma_f32_16x16x32_bf16 v[24:27], v[136:139], v[76:79], v[24:27]
    v_mfma_f32_16x16x32_bf16 v[28:31], v[140:143], v[76:79], v[28:31]
    s_waitcnt vmcnt(3)
    v_mfma_f32_16x16x32_bf16 v[16:19], v[144:147], v[80:83], v[16:19]
    v_mfma_f32_16x16x32_bf16 v[20:23], v[148:151], v[80:83], v[20:23]
    v_mfma_f32_16x16x32_bf16 v[24:27], v[152:155], v[80:83], v[24:27]
    v_mfma_f32_16x16x32_bf16 v[28:31], v[156:159], v[80:83], v[28:31]
    s_waitcnt vmcnt(2)
    s_waitcnt lgkmcnt(15)
    v_mfma_f32_16x16x32_bf16 v[16:19], v[160:163], v[84:87], v[16:19]
    v_mfma_f32_16x16x32_bf16 v[20:23], v[164:167], v[84:87], v[20:23]
    v_mfma_f32_16x16x32_bf16 v[24:27], v[168:171], v[84:87], v[24:27]
    v_mfma_f32_16x16x32_bf16 v[28:31], v[172:175], v[84:87], v[28:31]
    s_waitcnt vmcnt(1)
    s_waitcnt lgkmcnt(9)
    v_mfma_f32_16x16x32_bf16 v[16:19], v[176:179], v[88:91], v[16:19]
    v_mfma_f32_16x16x32_bf16 v[20:23], v[180:183], v[88:91], v[20:23]
    v_mfma_f32_16x16x32_bf16 v[24:27], v[184:187], v[88:91], v[24:27]
    v_mfma_f32_16x16x32_bf16 v[28:31], v[188:191], v[88:91], v[28:31]
    s_waitcnt vmcnt(0)
    s_waitcnt lgkmcnt(1)
    v_mfma_f32_16x16x32_bf16 v[16:19], v[192:195], v[92:95], v[16:19]
    v_mfma_f32_16x16x32_bf16 v[20:23], v[196:199], v[92:95], v[20:23]
    s_nop 6
    v_cvt_pk_bf16_f32 v32, v16, v17
    v_mfma_f32_16x16x32_bf16 v[24:27], v[200:203], v[92:95], v[24:27]
    v_cvt_pk_bf16_f32 v33, v18, v19
    v_cvt_pk_bf16_f32 v34, v20, v21
    v_mfma_f32_16x16x32_bf16 v[28:31], v[204:207], v[92:95], v[28:31]
    v_cvt_pk_bf16_f32 v35, v22, v23
    s_nop 3
    v_cvt_pk_bf16_f32 v36, v24, v25
    v_cvt_pk_bf16_f32 v37, v26, v27
    v_mfma_f32_16x16x32_bf16 v[68:71], v[32:35], v[32:35], 0
    v_cvt_pk_bf16_f32 v38, v28, v29
    v_cvt_pk_bf16_f32 v39, v30, v31
    v_mfma_f32_16x16x32_bf16 v[64:67], v[248:251], v[32:35], 0
    v_lshlrev_b32 v48, 16, v32
    v_mfma_f32_16x16x32_bf16 v[68:71], v[36:39], v[36:39], v[68:71]
    v_and_b32 v49, 0xffff0000, v32
    v_lshlrev_b32 v50, 16, v33
    v_mfma_f32_16x16x32_bf16 v[64:67], v[252:255], v[36:39], v[64:67]
    v_and_b32 v51, 0xffff0000, v33
    v_lshlrev_b32 v52, 16, v34
    v_and_b32 v53, 0xffff0000, v34
    s_nop 1
    v_cndmask_b32_e64 v68, v68, v69, s[28:29]
    v_cndmask_b32_e64 v70, v70, v71, s[28:29]
    s_nop 0
    v_mov_b32 v67, s72
    v_cndmask_b32_e64 v66, v68, v70, s[30:31]
    s_mov_b64 exec, s[32:33]

    s_cmp_lg_u32 s3, 0
    s_cbranch_scc1 L_ds_4p
    buffer_store_dwordx4 v[64:67], v9, s[40:43], s58 offen sc1
    s_branch L_ds_4q
    .p2alignl 6, 0xBF810000
    s_endpgm
    s_endpgm
    s_endpgm
    s_endpgm
    s_endpgm
    s_endpgm
    s_endpgm
    s_endpgm
    s_endpgm
    s_endpgm
    s_endpgm
    s_endpgm
L_ds_4p:
    buffer_store_dwordx4 v[64:67], v9, s[40:43], s58 offen
L_ds_4q:
    s_mov_b64 exec, -1
    v_lshlrev_b32 v54, 16, v35
    v_and_b32 v55, 0xffff0000, v35
    v_lshlrev_b32 v56, 16, v36
    v_and_b32 v57, 0xffff0000, v36
    v_lshlrev_b32 v58, 16, v37
    v_and_b32 v59, 0xffff0000, v37
    v_lshlrev_b32 v60, 16, v38
    v_and_b32 v61, 0xffff0000, v38
    v_lshlrev_b32 v62, 16, v39
    v_and_b32 v63, 0xffff0000, v39
    buffer_load_dwordx4 v[72:75], v1, s[40:43], s59 offen offset:0 sc1
    buffer_load_dwordx4 v[76:79], v1, s[40:43], s59 offen offset:1024 sc1
    v_mov_b32 v40, v35
    v_mov_b32 v41, v39
    v_mov_b32 v35, s72
    v_mov_b32 v99, s72
    v_mov_b32 v39, s72
    v_mov_b32 v103, s72
    v_mov_b32 v43, s72
    v_mov_b32 v107, s72
    v_lshlrev_b32 v13, 10, v13
    v_and_b32 v14, 16, v0
    v_lshl_add_u32 v13, v14, 1, v13
    v_lshrrev_b32 v14, 5, v0
    v_lshl_add_u32 v13, v14, 4, v13
    s_mov_b32 s76, 200000
L_st:
    s_waitcnt vmcnt(0)
    v_cmp_ne_u32 vcc, s72, v75
    v_cmp_ne_u32 s[14:15], s72, v79
    v_pk_add_f32 v[64:65], v[72:73], v[76:77]
    v_add_f32 v66, v74, v78
    s_or_b64 vcc, vcc, s[14:15]
    s_cbranch_vccz L_stok
    buffer_load_dwordx4 v[72:75], v1, s[40:43], s59 offen offset:0 sc1
    buffer_load_dwordx4 v[76:79], v1, s[40:43], s59 offen offset:1024 sc1
    s_sub_u32 s76, s76, 1
    s_cmp_lg_u32 s76, 0
    s_cbranch_scc1 L_st
L_stok:

    v_mov_b64 v[68:69], v[64:65]
    v_mov_b32 v70, v66
    s_nop 0
    v_permlane16_swap_b32 v64, v68
    v_permlane16_swap_b32 v66, v70
    v_permlane16_swap_b32 v65, v69
    v_add_f32 v64, v64, v68
    v_add_f32 v66, v66, v70
    v_add_f32 v65, v65, v69
    v_mov_b64 v[68:69], v[64:65]
    v_mov_b32 v70, v66
    s_nop 0
    v_permlane32_swap_b32 v64, v68
    v_permlane32_swap_b32 v66, v70
    v_permlane32_swap_b32 v65, v69
    v_add_f32 v64, v64, v68
    v_add_f32 v66, v66, v70
    v_add_f32 v65, v65, v69
    s_waitcnt lgkmcnt(0)
    v_mul_f32 v64, 0x3b000000, v64
    v_mul_f32 v66, 0x3b000000, v66
    v_fma_f32 v66, -v64, v64, v66
    v_max_f32 v66, 0, v66
    v_cvt_pk_bf16_f32 v66, v66, v66
    v_lshlrev_b32 v66, 16, v66
    v_cvt_pk_bf16_f32 v64, v64, v64
    v_lshlrev_b32 v64, 16, v64
    v_add_f32 v66, 0x3727c5ac, v66
    v_cvt_pk_bf16_f32 v66, v66, v66
    v_lshlrev_b32 v66, 16, v66
    v_sqrt_f32 v66, v66
    s_nop 0
    v_cvt_pk_bf16_f32 v66, v66, v66
    v_lshlrev_b32 v66, 16, v66
    v_rcp_f32 v68, v66
    s_nop 0
    v_mul_f32_e64 v69, -v64, v68
    v_mul_f32 v14, v15, v69
    v_fmac_f32 v14, v65, v68
    v_fma_f32 v108, v48, v68, v69
    v_ashrrev_i32 v15, 31, v14
    v_or_b32 v15, 0x80000000, v15
    v_xor_b32 v14, v14, v15
    v_and_b32 v14, 0xfffff800, v14
    v_or_b32 v106, v14, v12
    v_fma_f32 v109, v49, v68, v69
    v_fma_f32 v110, v50, v68, v69
    v_max_u32_dpp v14, v106, v106 quad_perm:[1,0,3,2] row_mask:0xf bank_mask:0xf

    v_fma_f32 v111, v51, v68, v69
    v_fma_f32 v112, v52, v68, v69
    v_max_u32_dpp v14, v14, v14 quad_perm:[2,3,0,1] row_mask:0xf bank_mask:0xf
    v_fma_f32 v113, v53, v68, v69
    v_fma_f32 v114, v54, v68, v69
    v_max_u32_dpp v14, v14, v14 row_half_mirror row_mask:0xf bank_mask:0xf
    v_fma_f32 v115, v55, v68, v69
    v_fma_f32 v116, v56, v68, v69
    v_max_u32_dpp v14, v14, v14 row_mirror row_mask:0xf bank_mask:0xf
    s_cmp_lt_u32 s69, 6
    v_cmp_eq_u32 s[34:35], v14, v106
    s_cbranch_scc1 L_nohdr
    s_mov_b64 exec, s[34:35]
    buffer_store_dwordx2 v[106:107], v11, s[40:43], s61 offen sc1
    s_mov_b64 exec, -1
L_nohdr:

    v_fma_f32 v117, v57, v68, v69
    v_fma_f32 v118, v58, v68, v69
    v_fma_f32 v119, v59, v68, v69
    v_fma_f32 v120, v60, v68, v69
    v_fma_f32 v121, v61, v68, v69
    v_fma_f32 v122, v62, v68, v69
    v_fma_f32 v123, v63, v68, v69
    v_cvt_pk_bf16_f32 v96, v108, v109
    v_cvt_pk_bf16_f32 v97, v110, v111
    v_cvt_pk_bf16_f32 v98, v112, v113
    v_cvt_pk_bf16_f32 v104, v114, v115
    v_cvt_pk_bf16_f32 v100, v116, v117
    v_cvt_pk_bf16_f32 v101, v118, v119
    v_cvt_pk_bf16_f32 v102, v120, v121
    v_cvt_pk_bf16_f32 v105, v122, v123
    s_mov_b64 exec, s[34:35]
    buffer_store_dwordx4 v[96:99], v10, s[40:43], s60 offen offset:0 sc1
    buffer_store_dwordx4 v[100:103], v10, s[40:43], s60 offen offset:16 sc1
    buffer_store_dwordx4 v[104:107], v10, s[40:43], s60 offen offset:32 sc1
    s_mov_b64 exec, -1
    s_barrier
    v_lshlrev_b32 v108, 16, v96
    v_and_b32 v109, 0xffff0000, v96
    v_lshlrev_b32 v110, 16, v97
    v_and_b32 v111, 0xffff0000, v97
    v_lshlrev_b32 v112, 16, v98
    v_and_b32 v113, 0xffff0000, v98
    v_lshlrev_b32 v114, 16, v104
    v_and_b32 v115, 0xffff0000, v104
    v_lshlrev_b32 v116, 16, v100
    v_and_b32 v117, 0xffff0000, v100
    v_lshlrev_b32 v118, 16, v101
    v_and_b32 v119, 0xffff0000, v101
    v_lshlrev_b32 v120, 16, v102
    v_and_b32 v121, 0xffff0000, v102
    v_lshlrev_b32 v122, 16, v105
    v_and_b32 v123, 0xffff0000, v105
    v_pk_add_f32 v[108:109], v[108:109], v[48:49]
    v_pk_add_f32 v[110:111], v[110:111], v[50:51]
    v_pk_add_f32 v[112:113], v[112:113], v[52:53]
    v_pk_add_f32 v[114:115], v[114:115], v[54:55]
    v_pk_add_f32 v[116:117], v[116:117], v[56:57]
    v_pk_add_f32 v[118:119], v[118:119], v[58:59]
    v_pk_add_f32 v[120:121], v[120:121], v[60:61]
    v_pk_add_f32 v[122:123], v[122:123], v[62:63]
    v_cvt_pk_bf16_f32 v72, v108, v109
    v_cvt_pk_bf16_f32 v73, v110, v111
    v_cvt_pk_bf16_f32 v74, v112, v113
    v_cvt_pk_bf16_f32 v75, v114, v115
    v_cvt_pk_bf16_f32 v76, v116, v117
    v_cvt_pk_bf16_f32 v77, v118, v119
    v_cvt_pk_bf16_f32 v78, v120, v121
    v_cvt_pk_bf16_f32 v79, v122, v123
    v_permlane16_swap_b32 v72, v74
    v_permlane16_swap_b32 v73, v75
    v_permlane16_swap_b32 v76, v78
    v_permlane16_swap_b32 v77, v79
    s_mov_b64 exec, s[34:35]
    buffer_store_dwordx4 v[72:75], v13, s[44:47], s62 offen offset:0 sc1
    buffer_store_dwordx4 v[76:79], v13, s[44:47], s62 offen offset:64 sc1
    s_not_b64 exec, s[34:35]
    buffer_store_dwordx4 v[72:75], v13, s[44:47], s62 offen offset:0
    buffer_store_dwordx4 v[76:79], v13, s[44:47], s62 offen offset:64
    s_mov_b64 exec, s[34:35]
    s_waitcnt vmcnt(2)
    buffer_store_dwordx4 v[32:35], v10, s[40:43], s60 offen offset:256 sc1
    buffer_store_dwordx4 v[36:39], v10, s[40:43], s60 offen offset:272 sc1
    buffer_store_dwordx4 v[40:43], v10, s[40:43], s60 offen offset:288 sc1
    s_branch L_fin
    .p2alignl 6, 0xBF810000
L_latt:
    ds_read_b128 v[172:175], v8
    ds_read_b128 v[176:179], v8 offset:4096

    s_waitcnt lgkmcnt(0)
    s_waitcnt vmcnt(12)
    v_mfma_f32_32x32x16_bf16 v[16:31], v[152:155], v[172:175], v[88:103]
    s_mov_b64 exec, 0xff07
    buffer_load_dword v82, v84, s[40:43], 0 offen sc1
    s_mov_b64 exec, -1
    s_waitcnt vmcnt(12)
    v_mfma_f32_32x32x16_bf16 v[32:47], v[156:159], v[172:175], 0
    s_nop 6
    v_exp_f32 v16, v16
    v_exp_f32 v17, v17
    v_exp_f32 v18, v18
    v_exp_f32 v19, v19
    s_and_b32 s4, s71, 3
    s_lshl_b32 s5, s68, 8
    s_lshl_b32 s101, s69, 4
    v_exp_f32 v20, v20
    v_exp_f32 v21, v21
    v_exp_f32 v22, v22
    v_exp_f32 v23, v23
    s_add_u32 s5, s5, s101
    s_lshl_b32 s101, s4, 2
    s_add_u32 s5, s5, s101
    v_cvt_pk_bf16_f32 v48, v16, v17
    v_cvt_pk_bf16_f32 v49, v18, v19
    v_cvt_pk_bf16_f32 v50, v20, v21
    v_cvt_pk_bf16_f32 v51, v22, v23
    v_exp_f32 v24, v24
    v_exp_f32 v25, v25
    v_exp_f32 v26, v26
    v_exp_f32 v27, v27
    s_add_u32 s5, s5, 7405568
    s_lshl_b32 s6, s69, 14
    s_lshl_b32 s101, s23, 7
    v_exp_f32 v28, v28
    v_exp_f32 v29, v29
    v_exp_f32 v30, v30
    v_exp_f32 v31, v31
    s_add_u32 s6, s6, s101
    s_add_u32 s6, s6, 7426048
    s_lshl_b32 s24, s23, 13
    v_cvt_pk_bf16_f32 v52, v24, v25
    v_cvt_pk_bf16_f32 v53, v26, v27
    v_cvt_pk_bf16_f32 v54, v28, v29
    v_cvt_pk_bf16_f32 v55, v30, v31
    v_mfma_f32_32x32x16_bf16 v[16:31], v[156:159], v[176:179], v[88:103]
    v_exp_f32 v32, v32
    v_exp_f32 v33, v33
    v_exp_f32 v34, v34
    v_exp_f32 v35, v35
    s_add_u32 s24, s24, 7557120
    s_lshl_b32 s101, s69, 10
    s_add_u32 s25, s24, s101
    v_exp_f32 v36, v36
    v_exp_f32 v37, v37
    v_exp_f32 v38, v38
    v_exp_f32 v39, v39
    s_add_u32 s28, s24, 4096
    s_lshl_b32 s26, s69, 9
    s_add_u32 s26, s26, 6553600
    v_cvt_pk_bf16_f32 v56, v32, v33
    v_cvt_pk_bf16_f32 v57, v34, v35
    v_cvt_pk_bf16_f32 v58, v36, v37
    v_cvt_pk_bf16_f32 v59, v38, v39
    v_exp_f32 v40, v40
    v_exp_f32 v41, v41
    v_exp_f32 v42, v42
    v_exp_f32 v43, v43
    s_lshl_b32 s27, s73, 14
    s_add_u32 s27, s27, 7819264
    s_and_b32 s29, s68, 7
    v_exp_f32 v44, v44
    v_exp_f32 v45, v45
    v_exp_f32 v46, v46
    v_exp_f32 v47, v47
    s_mov_b32 s30, 0xffff0000
    s_mov_b32 s31, 0xffff0000
    s_mov_b32 s32, 0
    v_cvt_pk_bf16_f32 v60, v40, v41
    v_cvt_pk_bf16_f32 v61, v42, v43
    v_cvt_pk_bf16_f32 v62, v44, v45
    v_cvt_pk_bf16_f32 v63, v46, v47
    s_waitcnt vmcnt(11)
    v_mfma_f32_32x32x16_bf16 v[32:47], v[160:163], v[172:175], 0
    s_waitcnt vmcnt(0)
    v_cmp_ne_u32 vcc, s72, v82
    v_cmp_eq_u32 s[14:15], s79, v82
    s_and_b64 vcc, vcc, s[12:13]
    s_cbranch_vccz L_vf0ok
    s_mov_b64 exec, s[12:13]

    s_mov_b32 s76, 200000
L_vf0:
    buffer_load_dword v82, v84, s[40:43], 0 offen sc1
    s_waitcnt vmcnt(0)
    v_cmp_ne_u32 vcc, s72, v82
    s_cbranch_vccz L_vf0ok
    s_sub_u32 s76, s76, 1
    s_cmp_lg_u32 s76, 0
    s_cbranch_scc1 L_vf0
L_vf0ok:
    s_mov_b64 exec, s[10:11]
    buffer_load_dwordx4 v[112:115], v104, s[40:43], 0 offen offset:1024 sc1
    buffer_load_dwordx4 v[116:119], v104, s[40:43], 0 offen offset:1280 sc1
    buffer_load_dwordx4 v[120:123], v105, s[40:43], 0 offen offset:1024 sc1
    buffer_load_dwordx4 v[124:127], v105, s[40:43], 0 offen offset:1280 sc1
    buffer_load_dwordx4 v[128:131], v106, s[40:43], 0 offen offset:1024 sc1
    buffer_load_dwordx4 v[132:135], v106, s[40:43], 0 offen offset:1280 sc1
    buffer_load_dwordx4 v[136:139], v107, s[40:43], 0 offen offset:1024 sc1
    buffer_load_dwordx4 v[140:143], v107, s[40:43], 0 offen offset:1280 sc1
    buffer_load_dwordx4 v[144:147], v108, s[40:43], 0 offen offset:1024 sc1
    buffer_load_dwordx4 v[148:151], v108, s[40:43], 0 offen offset:1280 sc1
    s_mov_b64 exec, -1
    s_and_b32 s14, s14, 0xff00
    s_cmp_eq_u32 s14, 65280
    s_cselect_b32 s3, 1, 0

    v_exp_f32 v16, v16
    v_exp_f32 v17, v17
    v_exp_f32 v18, v18
    v_exp_f32 v19, v19
    s_mov_b32 s33, -1
    s_mov_b64 s[34:35], -1
    v_exp_f32 v20, v20
    v_exp_f32 v21, v21
    v_exp_f32 v22, v22
    v_exp_f32 v23, v23
    v_cvt_pk_bf16_f32 v64, v16, v17
    v_cvt_pk_bf16_f32 v65, v18, v19
    v_cvt_pk_bf16_f32 v66, v20, v21
    v_cvt_pk_bf16_f32 v67, v22, v23
    v_exp_f32 v24, v24
    v_exp_f32 v25, v25
    v_exp_f32 v26, v26
    v_exp_f32 v27, v27
    v_exp_f32 v28, v28
    v_exp_f32 v29, v29
    v_exp_f32 v30, v30
    v_exp_f32 v31, v31
    v_cvt_pk_bf16_f32 v68, v24, v25
    v_cvt_pk_bf16_f32 v69, v26, v27
    v_cvt_pk_bf16_f32 v70, v28, v29
    v_cvt_pk_bf16_f32 v71, v30, v31
    v_mfma_f32_32x32x16_bf16 v[16:31], v[160:163], v[176:179], 0
    v_exp_f32 v32, v32
    v_exp_f32 v33, v33
    v_exp_f32 v34, v34
    v_exp_f32 v35, v35
    v_exp_f32 v36, v36
    v_exp_f32 v37, v37
    v_exp_f32 v38, v38
    v_exp_f32 v39, v39
    v_cvt_pk_bf16_f32 v72, v32, v33
    v_cvt_pk_bf16_f32 v73, v34, v35
    v_cvt_pk_bf16_f32 v74, v36, v37
    v_cvt_pk_bf16_f32 v75, v38, v39
    v_exp_f32 v40, v40
    v_exp_f32 v41, v41
    v_exp_f32 v42, v42
    v_exp_f32 v43, v43
    v_exp_f32 v44, v44
    v_exp_f32 v45, v45
    v_exp_f32 v46, v46
    v_exp_f32 v47, v47
    v_cvt_pk_bf16_f32 v76, v40, v41
    v_cvt_pk_bf16_f32 v77, v42, v43
    v_cvt_pk_bf16_f32 v78, v44, v45
    v_cvt_pk_bf16_f32 v79, v46, v47
    s_setprio 1
    v_mfma_f32_32x32x16_bf16 v[32:47], v[164:167], v[172:175], 0
    v_exp_f32 v16, v16
    v_exp_f32 v17, v17
    v_exp_f32 v18, v18
    v_exp_f32 v19, v19
    s_waitcnt vmcnt(9)
    v_mfma_f32_32x32x16_bf16 v[180:195], v[112:115], v[48:51], 0
    v_exp_f32 v20, v20
    v_exp_f32 v21, v21
    v_exp_f32 v22, v22
    v_exp_f32 v23, v23
    s_mov_b64 exec, 4194303
    buffer_load_dword v111, v111, s[40:43], 0 offen
    s_mov_b64 exec, -1
    s_waitcnt vmcnt(9)
    v_mfma_f32_32x32x16_bf16 v[180:195], v[116:119], v[52:55], v[180:195]
    v_cvt_pk_bf16_f32 v212, v16, v17
    v_cvt_pk_bf16_f32 v213, v18, v19
    v_cvt_pk_bf16_f32 v214, v20, v21
    v_cvt_pk_bf16_f32 v215, v22, v23
    v_exp_f32 v24, v24
    v_exp_f32 v25, v25
    v_exp_f32 v26, v26
    v_exp_f32 v27, v27
    s_waitcnt vmcnt(8)
    v_mfma_f32_32x32x16_bf16 v[180:195], v[120:123], v[56:59], v[180:195]
    v_exp_f32 v28, v28
    v_exp_f32 v29, v29
    v_exp_f32 v30, v30
    v_exp_f32 v31, v31
    s_add_u32 m0, s78, 20480
    s_nop 0
    buffer_load_dwordx4 v109, s[48:51], s64 offen offset:0 lds
    buffer_load_dwordx4 v109, s[48:51], s65 offen offset:1024 lds
    s_waitcnt vmcnt(9)
    v_mfma_f32_32x32x16_bf16 v[180:195], v[124:127], v[60:63], v[180:195]
    v_cvt_pk_bf16_f32 v216, v24, v25
    v_cvt_pk_bf16_f32 v217, v26, v27
    v_cvt_pk_bf16_f32 v218, v28, v29
    v_cvt_pk_bf16_f32 v219, v30, v31
    v_mfma_f32_32x32x16_bf16 v[16:31], v[164:167], v[176:179], 0
    v_exp_f32 v32, v32
    v_exp_f32 v33, v33
    v_exp_f32 v34, v34
    v_exp_f32 v35, v35
    v_mfma_f32_32x32x16_bf16 v[196:211], v[120:123], v[64:67], 0
    v_exp_f32 v36, v36
    v_exp_f32 v37, v37
    v_exp_f32 v38, v38
    v_exp_f32 v39, v39
    s_add_u32 m0, s78, 28672
    s_nop 0
    buffer_load_dwordx4 v109, s[52:55], s64 offen offset:0 lds
    buffer_load_dwordx4 v109, s[52:55], s65 offen offset:1024 lds
    v_mfma_f32_32x32x16_bf16 v[196:211], v[124:127], v[68:71], v[196:211]
    v_cvt_pk_bf16_f32 v220, v32, v33
    v_cvt_pk_bf16_f32 v221, v34, v35
    v_cvt_pk_bf16_f32 v222, v36, v37
    v_cvt_pk_bf16_f32 v223, v38, v39
    v_exp_f32 v40, v40
    v_exp_f32 v41, v41
    v_exp_f32 v42, v42
    v_exp_f32 v43, v43
    s_waitcnt vmcnt(10)
    v_mfma_f32_32x32x16_bf16 v[180:195], v[128:131], v[72:75], v[180:195]
    v_exp_f32 v44, v44
    v_exp_f32 v45, v45
    v_exp_f32 v46, v46
    v_exp_f32 v47, v47
    s_add_u32 m0, s78, 36864
    s_nop 0
    buffer_load_dwordx4 v110, s[56:59], s66 offen offset:0 lds
    buffer_load_dwordx4 v110, s[56:59], s67 offen offset:1024 lds
    s_waitcnt vmcnt(11)
    v_mfma_f32_32x32x16_bf16 v[180:195], v[132:135], v[76:79], v[180:195]
    v_cvt_pk_bf16_f32 v224, v40, v41
    v_cvt_pk_bf16_f32 v225, v42, v43
    v_cvt_pk_bf16_f32 v226, v44, v45
    v_cvt_pk_bf16_f32 v227, v46, v47
    v_mfma_f32_32x32x16_bf16 v[32:47], v[168:171], v[172:175], 0
    v_exp_f32 v16, v16
    v_exp_f32 v17, v17
    v_exp_f32 v18, v18
    v_exp_f32 v19, v19
    v_mfma_f32_32x32x16_bf16 v[196:211], v[128:131], v[212:215], v[196:211]
    v_exp_f32 v20, v20
    v_exp_f32 v21, v21
    v_exp_f32 v22, v22
    v_exp_f32 v23, v23
    v_mfma_f32_32x32x16_bf16 v[196:211], v[132:135], v[216:219], v[196:211]
    v_cvt_pk_bf16_f32 v228, v16, v17
    v_cvt_pk_bf16_f32 v229, v18, v19
    v_cvt_pk_bf16_f32 v230, v20, v21
    v_cvt_pk_bf16_f32 v231, v22, v23
    v_exp_f32 v24, v24
    v_exp_f32 v25, v25
    v_exp_f32 v26, v26
    v_exp_f32 v27, v27
    s_waitcnt vmcnt(10)
    v_mfma_f32_32x32x16_bf16 v[180:195], v[136:139], v[220:223], v[180:195]
    v_exp_f32 v28, v28
    v_exp_f32 v29, v29
    v_exp_f32 v30, v30
    v_exp_f32 v31, v31
    s_waitcnt vmcnt(9)
    v_mfma_f32_32x32x16_bf16 v[180:195], v[140:143], v[224:227], v[180:195]
    v_cvt_pk_bf16_f32 v232, v24, v25
    v_cvt_pk_bf16_f32 v233, v26, v27
    v_cvt_pk_bf16_f32 v234, v28, v29
    v_cvt_pk_bf16_f32 v235, v30, v31
    v_mfma_f32_32x32x16_bf16 v[16:31], v[168:171], v[176:179], 0
    v_exp_f32 v32, v32
    v_exp_f32 v33, v33
    v_exp_f32 v34, v34
    v_exp_f32 v35, v35
    v_mfma_f32_32x32x16_bf16 v[196:211], v[136:139], v[228:231], v[196:211]
    v_exp_f32 v36, v36
    v_exp_f32 v37, v37
    v_exp_f32 v38, v38
    v_exp_f32 v39, v39
    v_mfma_f32_32x32x16_bf16 v[196:211], v[140:143], v[232:235], v[196:211]
    v_cvt_pk_bf16_f32 v48, v32, v33
    v_cvt_pk_bf16_f32 v49, v34, v35
    v_cvt_pk_bf16_f32 v50, v36, v37
    v_cvt_pk_bf16_f32 v51, v38, v39
    v_exp_f32 v40, v40
    v_exp_f32 v41, v41
    v_exp_f32 v42, v42
    v_exp_f32 v43, v43
    s_waitcnt vmcnt(8)
    v_mfma_f32_32x32x16_bf16 v[180:195], v[144:147], v[48:51], v[180:195]
    v_exp_f32 v44, v44
    v_exp_f32 v45, v45
    v_exp_f32 v46, v46
    v_exp_f32 v47, v47
    v_cvt_pk_bf16_f32 v52, v40, v41
    v_cvt_pk_bf16_f32 v53, v42, v43
    v_cvt_pk_bf16_f32 v54, v44, v45
    v_cvt_pk_bf16_f32 v55, v46, v47
    v_exp_f32 v16, v16
    v_exp_f32 v17, v17
    v_exp_f32 v18, v18
    v_exp_f32 v19, v19
    s_waitcnt vmcnt(7)
    v_mfma_f32_32x32x16_bf16 v[180:195], v[148:151], v[52:55], v[180:195]
    v_exp_f32 v20, v20
    v_exp_f32 v21, v21
    v_exp_f32 v22, v22
    v_exp_f32 v23, v23
    v_cvt_pk_bf16_f32 v56, v16, v17
    v_cvt_pk_bf16_f32 v57, v18, v19
    v_cvt_pk_bf16_f32 v58, v20, v21
    v_cvt_pk_bf16_f32 v59, v22, v23
    v_exp_f32 v24, v24
    v_exp_f32 v25, v25
    v_exp_f32 v26, v26
    v_exp_f32 v27, v27
    v_mfma_f32_32x32x16_bf16 v[196:211], v[144:147], v[56:59], v[196:211]
    v_exp_f32 v28, v28
    v_exp_f32 v29, v29
    v_exp_f32 v30, v30
    v_exp_f32 v31, v31
    v_cvt_pk_bf16_f32 v60, v24, v25
    v_cvt_pk_bf16_f32 v61, v26, v27
    v_cvt_pk_bf16_f32 v62, v28, v29
    v_cvt_pk_bf16_f32 v63, v30, v31
    s_nop 1
    v_mfma_f32_32x32x16_bf16 v[196:211], v[148:151], v[60:63], v[196:211]
    s_setprio 0
    s_and_b32 s9, s71, 3
    s_mul_i32 s7, s9, 4608
    v_add_u32 v8, s7, v1
    v_lshl_add_u32 v9, v0, 2, s7

    ds_write_b32 v9, v188 offset:2048
    ds_write_b128 v8, v[180:183] offset:0
    ds_write_b128 v8, v[184:187] offset:1024
    s_nop 3
    ds_write_b32 v9, v204 offset:4352
    ds_write_b128 v8, v[196:199] offset:2304
    ds_write_b128 v8, v[200:203] offset:3328
    s_waitcnt lgkmcnt(0)
    s_barrier
    v_add_u32 v9, 151552, v1
    ds_read_b128 v[16:19], v9
    v_mov_b32 v9, s72
    v_mov_b32 v20, 0
    v_mov_b32 v21, 0x3f803f80
    s_waitcnt lgkmcnt(0)

    v_dot2c_f32_bf16 v20, v16, v21
    v_dot2c_f32_bf16 v20, v17, v21
    v_dot2c_f32_bf16 v20, v18, v21
    v_dot2c_f32_bf16 v20, v19, v21
    s_nop 2
    v_add_f32_dpp v20, v20, v20 quad_perm:[1,0,3,2] row_mask:0xf bank_mask:0xf
    s_nop 1
    v_add_f32_dpp v20, v20, v20 quad_perm:[2,3,0,1] row_mask:0xf bank_mask:0xf
    s_nop 1
    v_add_f32_dpp v20, v20, v20 row_half_mirror row_mask:0xf bank_mask:0xf
    s_nop 1
    v_add_f32_dpp v20, v20, v20 row_mirror row_mask:0xf bank_mask:0xf
    v_mov_b32 v21, v20
    s_nop 1
    v_permlane16_swap_b32 v20, v21
    v_add_f32 v20, v20, v21
    v_mov_b32 v21, v20
    s_nop 1
    v_permlane32_swap_b32 v20, v21
    v_add_f32 v20, v20, v21
    v_mov_b32 v21, 153664
    ds_write_b32 v21, v20
    v_and_b32 v10, 3, v0
    v_lshlrev_b32 v10, 3, v10
    v_lshrrev_b32 v11, 2, v0
    v_lshl_add_u32 v96, v11, 7, v10
    v_and_b32 v12, 0x18, v0
    v_lshl_add_u32 v96, v12, 2, v96
    v_add_u32 v96, 20480, v96
    v_and_b32 v11, 3, v11
    v_lshl_add_u32 v100, v11, 7, v10
    v_and_b32 v12, 8, v0
    v_lshl_add_u32 v100, v12, 2, v100
    v_and_b32 v8, 0x30, v0
    v_lshl_add_u32 v100, v8, 7, v100
    v_add_u32 v100, 36864, v100
    v_and_b32 v10, 15, v0
    v_lshlrev_b32 v10, 3, v10
    v_lshl_add_u32 v5, v8, 8, v10
    v_lshlrev_b32 v8, 2, v8
    v_mov_b32 v9, 0
    v_mov_b32 v62, s72
    s_mov_b32 s16, 0
    s_mov_b32 s18, s26
    s_mov_b32 s76, 200000

    v_xor_b32 v97, 32, v96
    v_xor_b32 v101, 32, v100
    v_xor_b32 v98, 64, v96
    v_xor_b32 v102, 64, v100
    v_xor_b32 v99, 96, v96
    v_xor_b32 v103, 96, v100
    s_waitcnt lgkmcnt(0)
    s_barrier
    s_waitcnt vmcnt(0)
    s_cmp_lg_u32 s4, 0
    s_barrier
    s_cbranch_scc1 L_fin

    v_lshrrev_b32 v7, 1, v0
    v_mul_u32_u24 v7, 96, v7
    v_add_u32 v7, v7, v1
    ds_read_b64_tr_b16 v[112:113], v96 offset:0
    ds_read_b64_tr_b16 v[114:115], v96 offset:2048
    ds_read_b64_tr_b16 v[116:117], v96 offset:4096
    ds_read_b64_tr_b16 v[118:119], v96 offset:6144
    ds_read_b64_tr_b16 v[120:121], v97 offset:0
    ds_read_b64_tr_b16 v[122:123], v97 offset:2048
    ds_read_b64_tr_b16 v[124:125], v97 offset:4096
    ds_read_b64_tr_b16 v[126:127], v97 offset:6144
    ds_read_b64_tr_b16 v[128:129], v98 offset:0
    ds_read_b64_tr_b16 v[130:131], v98 offset:2048
    ds_read_b64_tr_b16 v[132:133], v98 offset:4096
    ds_read_b64_tr_b16 v[134:135], v98 offset:6144
    ds_read_b64_tr_b16 v[136:137], v99 offset:0
    ds_read_b64_tr_b16 v[138:139], v99 offset:2048
    ds_read_b64_tr_b16 v[140:141], v99 offset:4096
    ds_read_b64_tr_b16 v[142:143], v99 offset:6144
    ds_read_b64_tr_b16 v[144:145], v96 offset:8192
    ds_read_b64_tr_b16 v[146:147], v96 offset:10240
    ds_read_b64_tr_b16 v[148:149], v96 offset:12288
    ds_read_b64_tr_b16 v[150:151], v96 offset:14336
    ds_read_b64_tr_b16 v[152:153], v97 offset:8192
    ds_read_b64_tr_b16 v[154:155], v97 offset:10240
    ds_read_b64_tr_b16 v[156:157], v97 offset:12288
    ds_read_b64_tr_b16 v[158:159], v97 offset:14336
    ds_read_b64_tr_b16 v[160:161], v98 offset:8192
    ds_read_b64_tr_b16 v[162:163], v98 offset:10240
    ds_read_b64_tr_b16 v[164:165], v98 offset:12288
    ds_read_b64_tr_b16 v[166:167], v98 offset:14336
    ds_read_b64_tr_b16 v[168:169], v99 offset:8192
    ds_read_b64_tr_b16 v[170:171], v99 offset:10240
    ds_read_b64_tr_b16 v[172:173], v99 offset:12288
    ds_read_b64_tr_b16 v[174:175], v99 offset:14336
    ds_read_b64_tr_b16 v[176:177], v100 offset:0
    ds_read_b64_tr_b16 v[178:179], v102 offset:512
    ds_read_b64_tr_b16 v[180:181], v100 offset:1024
    ds_read_b64_tr_b16 v[182:183], v102 offset:1536
    ds_read_b64_tr_b16 v[184:185], v101 offset:0
    ds_read_b64_tr_b16 v[186:187], v103 offset:512
    ds_read_b64_tr_b16 v[188:189], v101 offset:1024
    ds_read_b64_tr_b16 v[190:191], v103 offset:1536
    ds_read_b64_tr_b16 v[192:193], v102 offset:0
    ds_read_b64_tr_b16 v[194:195], v100 offset:512
    ds_read_b64_tr_b16 v[196:197], v102 offset:1024
    ds_read_b64_tr_b16 v[198:199], v100 offset:1536
    ds_read_b64_tr_b16 v[200:201], v103 offset:0
    ds_read_b64_tr_b16 v[202:203], v101 offset:512
    ds_read_b64_tr_b16 v[204:205], v103 offset:1024
    ds_read_b64_tr_b16 v[206:207], v101 offset:1536
    s_waitcnt lgkmcnt(0)
    buffer_load_dwordx4 v[16:19], v7, s[40:43], s27 offen sc1
    buffer_load_dwordx4 v[48:51], v8, s[40:43], s18 offen offset:0 sc1
    buffer_load_dwordx4 v[52:55], v8, s[40:43], s18 offen offset:16 sc1
    buffer_load_dwordx4 v[56:59], v8, s[40:43], s18 offen offset:32 sc1
    s_waitcnt lgkmcnt(0)
L_ch:
    s_waitcnt vmcnt(0)
    s_mov_b32 s19, 0
    v_cmp_eq_u32 vcc, s72, v17
    v_cmp_eq_u32 s[14:15], s72, v19
    s_nop 0
    v_cndmask_b32 v10, 0, v16, vcc
    v_cndmask_b32_e64 v11, 0, v18, s[14:15]
    s_and_b64 vcc, vcc, s[14:15]
    v_max3_u32 v9, v9, v10, v11
    s_andn2_b64 s[34:35], s[34:35], vcc
    s_cbranch_scc0 L_hx
    s_mov_b64 exec, s[34:35]
    buffer_load_dwordx4 v[16:19], v7, s[40:43], s27 offen sc1
    s_mov_b64 exec, -1

    v_cmp_lt_u32 vcc, s16, v9
    s_cbranch_vccz L_hs
    v_max_u32_dpp v10, v9, v9 quad_perm:[1,0,3,2] row_mask:0xf bank_mask:0xf
    s_nop 1
    v_max_u32_dpp v10, v10, v10 quad_perm:[2,3,0,1] row_mask:0xf bank_mask:0xf
    s_nop 1
    v_max_u32_dpp v10, v10, v10 row_half_mirror row_mask:0xf bank_mask:0xf
    s_nop 1
    v_max_u32_dpp v10, v10, v10 row_mirror row_mask:0xf bank_mask:0xf
    s_nop 0
    v_readlane_b32 s16, v10, 0
    v_readlane_b32 s17, v10, 16
    v_readlane_b32 s18, v10, 32
    v_readlane_b32 s19, v10, 48
    s_max_u32 s16, s16, s17
    s_max_u32 s18, s18, s19
    s_max_u32 s16, s16, s18
    s_bfe_u32 s18, s16, 458756
    s_lshl_b32 s18, s18, 12
    s_add_u32 s18, s18, s26

    s_branch L_hi
L_hs:
    v_xor_b32 v10, s72, v51
    v_bitop3_b32 v10, v10, v55, s72 bitop3:0xf6
    v_bitop3_b32 v10, v10, v59, s72 bitop3:0xf6
    v_cmp_ne_u32 vcc, 0, v10
    s_cbranch_vccnz L_hi
    s_mov_b64 exec, 0
    s_branch L_hl
L_hi:
    s_mov_b32 s19, 1
L_hl:
    buffer_load_dwordx4 v[48:51], v8, s[40:43], s18 offen offset:0 sc1
    buffer_load_dwordx4 v[52:55], v8, s[40:43], s18 offen offset:16 sc1
    buffer_load_dwordx4 v[56:59], v8, s[40:43], s18 offen offset:32 sc1
    s_mov_b64 exec, -1

    s_sub_u32 s76, s76, 1
    s_cmp_lg_u32 s76, 0
    s_cbranch_scc1 L_ch
L_hx:

    v_cmp_lt_u32 vcc, s16, v9
    s_cbranch_vccz L_hy
    v_max_u32_dpp v10, v9, v9 quad_perm:[1,0,3,2] row_mask:0xf bank_mask:0xf
    s_nop 1
    v_max_u32_dpp v10, v10, v10 quad_perm:[2,3,0,1] row_mask:0xf bank_mask:0xf
    s_nop 1
    v_max_u32_dpp v10, v10, v10 row_half_mirror row_mask:0xf bank_mask:0xf
    s_nop 1
    v_max_u32_dpp v10, v10, v10 row_mirror row_mask:0xf bank_mask:0xf
    s_nop 0
    v_readlane_b32 s16, v10, 0
    v_readlane_b32 s17, v10, 16
    v_readlane_b32 s18, v10, 32
    v_readlane_b32 s19, v10, 48
    s_max_u32 s16, s16, s17
    s_max_u32 s18, s18, s19
    s_max_u32 s16, s16, s18
    s_bfe_u32 s18, s16, 458756
    s_lshl_b32 s18, s18, 12
    s_add_u32 s18, s18, s26

    s_mov_b32 s19, 2
L_hy:
    s_cmp_eq_u32 s29, 7
    s_cbranch_scc1 L_nf2
    s_mov_b32 s76, 200000
    s_cmp_eq_u32 s19, 0
    s_cbranch_scc1 L_xc
    s_cmp_eq_u32 s19, 1
    s_cbranch_scc1 L_xw
L_xr:
    buffer_load_dwordx4 v[48:51], v8, s[40:43], s18 offen offset:0 sc1
    buffer_load_dwordx4 v[52:55], v8, s[40:43], s18 offen offset:16 sc1
    buffer_load_dwordx4 v[56:59], v8, s[40:43], s18 offen offset:32 sc1
L_xw:
    s_waitcnt vmcnt(0)
L_xc:

    v_xor_b32 v10, s72, v51
    v_bitop3_b32 v10, v10, v55, s72 bitop3:0xf6
    v_bitop3_b32 v10, v10, v59, s72 bitop3:0xf6
    v_cmp_ne_u32 vcc, 0, v10
    v_mov_b32 v51, v56
    v_mov_b32 v55, v57
    s_cbranch_vccz L_xrok
    s_sub_u32 s76, s76, 1
    s_cmp_lg_u32 s76, 0
    s_cbranch_scc1 L_xr
L_xrok:
    v_mfma_f32_16x16x32_bf16 v[64:67], v[48:51], v[112:115], 0
    v_mfma_f32_16x16x32_bf16 v[68:71], v[48:51], v[120:123], 0
    v_mfma_f32_16x16x32_bf16 v[72:75], v[48:51], v[128:131], 0
    v_mfma_f32_16x16x32_bf16 v[76:79], v[48:51], v[136:139], 0
    v_mfma_f32_16x16x32_bf16 v[64:67], v[52:55], v[116:119], v[64:67]
    v_mfma_f32_16x16x32_bf16 v[68:71], v[52:55], v[124:127], v[68:71]
    v_mfma_f32_16x16x32_bf16 v[72:75], v[52:55], v[132:135], v[72:75]
    v_mfma_f32_16x16x32_bf16 v[76:79], v[52:55], v[140:143], v[76:79]
    v_mfma_f32_16x16x32_bf16 v[80:83], v[48:51], v[144:147], 0
    v_mfma_f32_16x16x32_bf16 v[84:87], v[48:51], v[152:155], 0
    v_mfma_f32_16x16x32_bf16 v[88:91], v[48:51], v[160:163], 0
    v_mfma_f32_16x16x32_bf16 v[92:95], v[48:51], v[168:171], 0
    v_mfma_f32_16x16x32_bf16 v[80:83], v[52:55], v[148:151], v[80:83]
    v_mfma_f32_16x16x32_bf16 v[84:87], v[52:55], v[156:159], v[84:87]
    v_mfma_f32_16x16x32_bf16 v[88:91], v[52:55], v[164:167], v[88:91]
    v_mfma_f32_16x16x32_bf16 v[92:95], v[52:55], v[172:175], v[92:95]
    v_cndmask_b32_e64 v60, v64, v68, s[30:31]
    v_cndmask_b32_e64 v10, v72, v76, s[30:31]
    v_cndmask_b32_e64 v60, v60, v10, s[32:33]
    s_nop 2
    v_cndmask_b32_e64 v61, v80, v84, s[30:31]
    s_nop 0
    v_cndmask_b32_e64 v11, v88, v92, s[30:31]
    v_cndmask_b32_e64 v61, v61, v11, s[32:33]
    s_cmp_lg_u32 s3, 0
    s_cbranch_scc1 L_ds_1001p
    buffer_store_dwordx4 v[60:63], v1, s[40:43], s25 offen sc1
    s_branch L_ds_1001q
L_ds_1001p:
    buffer_store_dwordx4 v[60:63], v1, s[40:43], s25 offen
L_ds_1001q:
    s_mov_b32 s76, 200000
L_gu:
    buffer_load_dwordx3 v[208:210], v1, s[40:43], s24 offen offset:0 sc1
    buffer_load_dwordx3 v[212:214], v1, s[40:43], s24 offen offset:1024 sc1
    buffer_load_dwordx3 v[216:218], v1, s[40:43], s24 offen offset:2048 sc1
    buffer_load_dwordx3 v[220:222], v1, s[40:43], s24 offen offset:3072 sc1
    buffer_load_dwordx3 v[224:226], v1, s[40:43], s28 offen offset:0 sc1
    buffer_load_dwordx3 v[228:230], v1, s[40:43], s28 offen offset:1024 sc1
    buffer_load_dwordx3 v[232:234], v1, s[40:43], s28 offen offset:2048 sc1
    buffer_load_dwordx3 v[236:238], v1, s[40:43], s28 offen offset:3072 sc1
    s_waitcnt vmcnt(4)
    v_xor_b32 v10, s72, v210
    v_bitop3_b32 v10, v10, v214, s72 bitop3:0xf6
    v_bitop3_b32 v10, v10, v218, s72 bitop3:0xf6
    v_bitop3_b32 v10, v10, v222, s72 bitop3:0xf6
    v_pk_add_f32 v[64:65], v[208:209], v[212:213]
    v_pk_add_f32 v[66:67], v[216:217], v[220:221]
    v_pk_add_f32 v[64:65], v[64:65], v[66:67]
    s_waitcnt vmcnt(0)
    v_pk_add_f32 v[66:67], v[224:225], v[228:229]
    v_pk_add_f32 v[68:69], v[232:233], v[236:237]
    v_bitop3_b32 v10, v10, v226, s72 bitop3:0xf6
    v_bitop3_b32 v10, v10, v230, s72 bitop3:0xf6
    v_bitop3_b32 v10, v10, v234, s72 bitop3:0xf6
    v_bitop3_b32 v10, v10, v238, s72 bitop3:0xf6
    v_pk_add_f32 v[64:65], v[64:65], v[66:67]
    v_cmp_ne_u32 vcc, 0, v10
    v_pk_add_f32 v[64:65], v[64:65], v[68:69]
    s_cbranch_vccz L_guok
    s_sub_u32 s76, s76, 1
    s_cmp_lg_u32 s76, 0
    s_cbranch_scc1 L_gu
L_guok:
    v_cvt_pk_bf16_f32 v64, v64, v65
    v_and_b32 v65, 0xffff0000, v64
    v_lshlrev_b32 v64, 16, v64
    v_mul_f32 v66, 0xbfb8aa3b, v64
    v_exp_f32 v66, v66
    v_mov_b32 v61, s72
    v_add_f32 v66, 1.0, v66
    v_rcp_f32 v66, v66
    s_nop 0
    v_mul_f32 v64, v64, v66

    v_cvt_pk_bf16_f32 v64, v64, v64
    v_lshlrev_b32 v64, 16, v64
    v_mul_f32 v64, v64, v65
    s_nop 1
    v_mov_b32_dpp v65, v64 quad_perm:[1,0,3,2] row_mask:0xf bank_mask:0xf
    v_cvt_pk_bf16_f32 v63, v64, v65

    s_nop 1
    v_mov_b32_dpp v64, v63 row_newbcast:0 row_mask:0xf bank_mask:0xf
    v_mov_b32_dpp v65, v63 row_newbcast:2 row_mask:0xf bank_mask:0xf
    v_mov_b32_dpp v66, v63 row_newbcast:4 row_mask:0xf bank_mask:0xf
    v_mov_b32_dpp v67, v63 row_newbcast:6 row_mask:0xf bank_mask:0xf
    v_mov_b32_dpp v68, v63 row_newbcast:8 row_mask:0xf bank_mask:0xf
    v_mov_b32_dpp v69, v63 row_newbcast:10 row_mask:0xf bank_mask:0xf
    v_mov_b32_dpp v70, v63 row_newbcast:12 row_mask:0xf bank_mask:0xf
    v_mov_b32_dpp v71, v63 row_newbcast:14 row_mask:0xf bank_mask:0xf
    v_mfma_f32_16x16x32_bf16 v[72:75], v[64:67], v[176:179], 0
    v_mfma_f32_16x16x32_bf16 v[76:79], v[64:67], v[184:187], 0
    v_mfma_f32_16x16x32_bf16 v[80:83], v[64:67], v[192:195], 0
    v_mfma_f32_16x16x32_bf16 v[84:87], v[64:67], v[200:203], 0
    v_mfma_f32_16x16x32_bf16 v[72:75], v[68:71], v[180:183], v[72:75]
    v_mfma_f32_16x16x32_bf16 v[76:79], v[68:71], v[188:191], v[76:79]
    v_mfma_f32_16x16x32_bf16 v[80:83], v[68:71], v[196:199], v[80:83]
    v_mfma_f32_16x16x32_bf16 v[84:87], v[68:71], v[204:207], v[84:87]
    s_nop 5
    v_cndmask_b32_e64 v60, v72, v76, s[30:31]
    s_nop 0
    v_cndmask_b32_e64 v10, v80, v84, s[30:31]
    v_cndmask_b32_e64 v60, v60, v10, s[32:33]
    buffer_store_dwordx2 v[60:61], v5, s[40:43], s6 offen sc1
    s_branch L_fin

L_nf2:
    s_lshr_b32 s5, s68, 3
    s_lshl_b32 s20, s5, 1
    v_and_b32 v10, 1, v0
    v_add_u32 v10, s20, v10
    v_lshrrev_b32 v11, 2, v10
    v_add_u32 v11, 8, v11
    v_and_b32 v12, 3, v10
    v_cmp_eq_u32 vcc, 3, v12
    s_nop 1
    v_cndmask_b32 v10, v10, v11, vcc
    v_and_b32 v11, 12, v10
    v_lshlrev_b32 v11, 2, v11
    v_and_b32 v12, 14, v0
    v_lshl_add_u32 v8, v12, 5, v11
    v_and_b32 v10, 3, v10
    v_cmp_eq_u32 s[30:31], 1, v10
    v_cmp_eq_u32 s[32:33], 2, v10
    s_lshl_b32 s6, s69, 14
    s_lshl_b32 s20, s5, 12
    s_add_u32 s6, s6, s20
    s_add_u32 s6, s6, 7426048
    s_and_b32 s19, s16, 0xfffff800
    s_add_u32 s19, s19, 0x400
    s_ashr_i32 s20, s19, 31
    s_not_b32 s20, s20
    s_or_b32 s20, s20, 0x80000000
    s_xor_b32 s19, s19, s20
    v_mov_b32 v13, s19

    v_cvt_pk_bf16_f32 v13, v13, v13
    v_lshlrev_b32 v13, 16, v13
    v_mul_f32 v13, 0xbfb8aa3b, v13
    v_exp_f32 v13, v13
    v_lshlrev_b32 v11, 2, v0
    v_add_f32 v13, 1.0, v13
    v_rcp_f32 v13, v13
    s_and_b32 s19, s16, 0x7ff
    s_lshl_b32 s19, s19, 10
    s_lshl_b32 s20, s69, 7
    s_add_u32 s19, s19, s20
    s_lshl_b32 s20, s5, 5
    s_add_u32 s19, s19, s20

    v_cvt_pk_bf16_f32 v13, v13, v13
    v_lshlrev_b32 v13, 16, v13
    v_mov_b32 v76, 0
    v_mov_b32 v77, s72
    v_mov_b32 v78, 0
    v_mov_b32 v79, s72
    s_mov_b32 s76, 200000
L_ft:
    buffer_load_dwordx4 v[4:7], v8, s[40:43], s18 offen sc1
    s_waitcnt vmcnt(0)
    v_cmp_ne_u32 vcc, s72, v7
    s_cbranch_vccz L_ftok
    s_sub_u32 s76, s76, 1
    s_cmp_lg_u32 s76, 0
    s_cbranch_scc1 L_ft
L_ftok:
    buffer_load_dwordx4 v[64:67], v1, s[40:43], s6 offen offset:0 sc1
    buffer_load_dwordx4 v[68:71], v1, s[40:43], s6 offen offset:1024 sc1
    buffer_load_dwordx4 v[72:75], v1, s[40:43], s6 offen offset:2048 sc1
    s_mov_b32 exec_hi, 0
    buffer_load_dwordx4 v[76:79], v1, s[40:43], s6 offen offset:3072 sc1
    s_mov_b32 exec_hi, -1
    v_cndmask_b32_e64 v14, v4, v5, s[30:31]
    v_cndmask_b32_e64 v14, v14, v6, s[32:33]
    s_nop 1
    v_mov_b32_dpp v15, v14 row_ror:8 row_mask:0xf bank_mask:0xf
    v_lshlrev_b32 v4, 16, v14
    v_and_b32 v5, 0xffff0000, v14
    v_lshlrev_b32 v6, 16, v15
    v_and_b32 v7, 0xffff0000, v15
    s_mov_b32 s76, 200000
L_pt:
    s_waitcnt vmcnt(0)
    v_xor_b32 v10, s72, v65
    v_bitop3_b32 v10, v10, v67, s72 bitop3:0xf6
    v_bitop3_b32 v10, v10, v69, s72 bitop3:0xf6
    v_bitop3_b32 v10, v10, v71, s72 bitop3:0xf6
    v_bitop3_b32 v10, v10, v73, s72 bitop3:0xf6
    v_bitop3_b32 v10, v10, v75, s72 bitop3:0xf6
    v_bitop3_b32 v10, v10, v77, s72 bitop3:0xf6
    v_bitop3_b32 v10, v10, v79, s72 bitop3:0xf6
    v_cmp_ne_u32 vcc, 0, v10
    s_cbranch_vccz L_fx0
    buffer_load_dwordx4 v[64:67], v1, s[40:43], s6 offen offset:0 sc1
    buffer_load_dwordx4 v[68:71], v1, s[40:43], s6 offen offset:1024 sc1
    buffer_load_dwordx4 v[72:75], v1, s[40:43], s6 offen offset:2048 sc1
    s_mov_b32 exec_hi, 0
    buffer_load_dwordx4 v[76:79], v1, s[40:43], s6 offen offset:3072 sc1
    s_mov_b32 exec_hi, -1
    s_sub_u32 s76, s76, 1
    s_cmp_lg_u32 s76, 0
    s_cbranch_scc1 L_pt
L_fx0:
    v_add_f32 v16, v64, v68
    v_add_f32 v17, v66, v70
    v_add_f32 v18, v72, v76
    v_add_f32 v19, v74, v78

L_fy:
    v_add_f32 v16, v16, v18
    v_add_f32 v17, v17, v19
    s_nop 0
    v_add_f32_dpp v16, v16, v16 row_ror:8 row_mask:0xf bank_mask:0xf
    v_add_f32_dpp v17, v17, v17 row_ror:8 row_mask:0xf bank_mask:0xf
    v_mov_b32 v18, v16
    v_mov_b32 v19, v17
    s_nop 0
    v_permlane16_swap_b32 v16, v18
    v_permlane16_swap_b32 v17, v19
    v_add_f32 v16, v16, v18
    v_add_f32 v17, v17, v19
    v_mov_b32 v18, v16
    v_mov_b32 v19, v17
    s_nop 0
    v_permlane32_swap_b32 v16, v18
    v_permlane32_swap_b32 v17, v19
    v_add_f32 v16, v16, v18
    v_add_f32 v17, v17, v19
    v_cvt_pk_bf16_f32 v16, v16, v17
    v_and_b32 v17, 0xffff0000, v16
    v_lshlrev_b32 v16, 16, v16
    v_mul_f32 v16, v16, v13
    v_mul_f32 v17, v17, v13
    v_cvt_pk_bf16_f32 v16, v16, v17
    v_and_b32 v17, 0xffff0000, v16
    v_lshlrev_b32 v16, 16, v16
    v_add_f32 v16, v16, v4
    v_add_f32 v17, v17, v5
    v_cvt_pk_bf16_f32 v16, v16, v17
    v_and_b32 v17, 0xffff0000, v16
    v_lshlrev_b32 v16, 16, v16
    v_add_f32 v16, v16, v6
    v_add_f32 v17, v17, v7
    v_cvt_pk_bf16_f32 v16, v16, v17
    s_mov_b64 exec, 0xff
    buffer_store_dword v16, v11, s[44:47], s19 offen

L_fin:
L_end:
    s_endpgm
L_slow0:
    v_and_b32 v8, 31, v0
    v_lshrrev_b32 v9, 5, v0
    v_lshlrev_b32 v9, 2, v9
    v_sub_u32 v8, v8, v9
    v_mov_b32 v10, 0xf149f2ca
    v_mov_b32 v11, 0xf149f2ca
    s_add_u32 s14, s18, 0
    s_movk_i32 s20, 256

    v_mov_b32 v180, 0
    v_mov_b32 v48, 0
    v_mov_b32 v181, 0
    v_mov_b32 v49, 0
    v_mov_b32 v182, 0
    v_mov_b32 v50, 0
    v_mov_b32 v183, 0
    v_mov_b32 v51, 0
    v_mov_b32 v184, 0
    v_mov_b32 v52, 0
    v_mov_b32 v185, 0
    v_mov_b32 v53, 0
    v_mov_b32 v186, 0
    v_mov_b32 v54, 0
    v_mov_b32 v187, 0
    v_mov_b32 v55, 0
    v_mov_b32 v188, 0
    v_mov_b32 v56, 0
    v_mov_b32 v189, 0
    v_mov_b32 v57, 0
    v_mov_b32 v190, 0
    v_mov_b32 v58, 0
    v_mov_b32 v191, 0
    v_mov_b32 v59, 0
    v_mov_b32 v192, 0
    v_mov_b32 v60, 0
    v_mov_b32 v193, 0
    v_mov_b32 v61, 0
    v_mov_b32 v194, 0
    v_mov_b32 v62, 0
    v_mov_b32 v195, 0
    v_mov_b32 v63, 0
    v_mov_b32 v64, 0x3f803f80
    v_mov_b32 v65, 0x3f803f80
    v_mov_b32 v66, 0x3f803f80
    v_mov_b32 v67, 0x3f803f80
    v_mov_b32 v68, 0x3f803f80
    v_mov_b32 v69, 0x3f803f80
    v_mov_b32 v70, 0x3f803f80
    v_mov_b32 v71, 0x3f803f80
    s_mov_b32 s21, 0
L_sp0:
    s_mov_b32 s15, 0
L_sl0:
    s_sub_u32 s22, s14, s15
    s_lshl_b32 s22, s22, 13
    s_add_u32 s22, s22, s19
    buffer_load_dwordx4 v[152:155], v1, s[40:43], s22 offen sc1
    s_mov_b64 exec, s[10:11]
    buffer_load_dwordx4 v[64:67], v1, s[40:43], s22 offen offset:1024 sc1
    buffer_load_dwordx4 v[68:71], v1, s[40:43], s22 offen offset:1280 sc1
    s_mov_b64 exec, -1
    s_lshl_b32 s22, s15, 5
    v_add_u32 v9, s22, v8
    s_waitcnt vmcnt(0)
    v_mfma_f32_32x32x16_bf16 v[16:31], v[152:155], v[172:175], v[48:63]

    v_subrev_u32 v12, 0, v9
    v_cmp_gt_u32 vcc, s20, v12
    s_nop 9
    v_cndmask_b32 v16, v10, v16, vcc
    v_max_f32 v11, v11, v16
    v_exp_f32 v16, v16

    v_subrev_u32 v12, 1, v9
    v_cmp_gt_u32 vcc, s20, v12
    s_nop 1
    v_cndmask_b32 v17, v10, v17, vcc
    v_max_f32 v11, v11, v17
    v_exp_f32 v17, v17

    v_subrev_u32 v12, 2, v9
    v_cmp_gt_u32 vcc, s20, v12
    s_nop 1
    v_cndmask_b32 v18, v10, v18, vcc
    v_max_f32 v11, v11, v18
    v_exp_f32 v18, v18

    v_subrev_u32 v12, 3, v9
    v_cmp_gt_u32 vcc, s20, v12
    s_nop 1
    v_cndmask_b32 v19, v10, v19, vcc
    v_max_f32 v11, v11, v19
    v_exp_f32 v19, v19

    v_subrev_u32 v12, 8, v9
    v_cmp_gt_u32 vcc, s20, v12
    s_nop 1
    v_cndmask_b32 v20, v10, v20, vcc
    v_max_f32 v11, v11, v20
    v_exp_f32 v20, v20

    v_subrev_u32 v12, 9, v9
    v_cmp_gt_u32 vcc, s20, v12
    s_nop 1
    v_cndmask_b32 v21, v10, v21, vcc
    v_max_f32 v11, v11, v21
    v_exp_f32 v21, v21

    v_subrev_u32 v12, 10, v9
    v_cmp_gt_u32 vcc, s20, v12
    s_nop 1
    v_cndmask_b32 v22, v10, v22, vcc
    v_max_f32 v11, v11, v22
    v_exp_f32 v22, v22

    v_subrev_u32 v12, 11, v9
    v_cmp_gt_u32 vcc, s20, v12
    s_nop 1
    v_cndmask_b32 v23, v10, v23, vcc
    v_max_f32 v11, v11, v23
    v_exp_f32 v23, v23

    v_subrev_u32 v12, 16, v9
    v_cmp_gt_u32 vcc, s20, v12
    s_nop 1
    v_cndmask_b32 v24, v10, v24, vcc
    v_max_f32 v11, v11, v24
    v_exp_f32 v24, v24

    v_subrev_u32 v12, 17, v9
    v_cmp_gt_u32 vcc, s20, v12
    s_nop 1
    v_cndmask_b32 v25, v10, v25, vcc
    v_max_f32 v11, v11, v25
    v_exp_f32 v25, v25

    v_subrev_u32 v12, 18, v9
    v_cmp_gt_u32 vcc, s20, v12
    s_nop 1
    v_cndmask_b32 v26, v10, v26, vcc
    v_max_f32 v11, v11, v26
    v_exp_f32 v26, v26

    v_subrev_u32 v12, 19, v9
    v_cmp_gt_u32 vcc, s20, v12
    s_nop 1
    v_cndmask_b32 v27, v10, v27, vcc
    v_max_f32 v11, v11, v27
    v_exp_f32 v27, v27

    v_subrev_u32 v12, 24, v9
    v_cmp_gt_u32 vcc, s20, v12
    s_nop 1
    v_cndmask_b32 v28, v10, v28, vcc
    v_max_f32 v11, v11, v28
    v_exp_f32 v28, v28

    v_subrev_u32 v12, 25, v9
    v_cmp_gt_u32 vcc, s20, v12
    s_nop 1
    v_cndmask_b32 v29, v10, v29, vcc
    v_max_f32 v11, v11, v29
    v_exp_f32 v29, v29

    v_subrev_u32 v12, 26, v9
    v_cmp_gt_u32 vcc, s20, v12
    s_nop 1
    v_cndmask_b32 v30, v10, v30, vcc
    v_max_f32 v11, v11, v30
    v_exp_f32 v30, v30

    v_subrev_u32 v12, 27, v9
    v_cmp_gt_u32 vcc, s20, v12
    s_nop 1
    v_cndmask_b32 v31, v10, v31, vcc
    v_max_f32 v11, v11, v31
    v_exp_f32 v31, v31

    v_cvt_pk_bf16_f32 v72, v16, v17
    v_cvt_pk_bf16_f32 v73, v18, v19
    v_cvt_pk_bf16_f32 v74, v20, v21
    v_cvt_pk_bf16_f32 v75, v22, v23
    v_cvt_pk_bf16_f32 v76, v24, v25
    v_cvt_pk_bf16_f32 v77, v26, v27
    v_cvt_pk_bf16_f32 v78, v28, v29
    v_cvt_pk_bf16_f32 v79, v30, v31
    s_cmp_eq_u32 s21, 0
    s_cbranch_scc1 L_sk0
    v_mfma_f32_32x32x16_bf16 v[180:195], v[64:67], v[72:75], v[180:195]
    v_mfma_f32_32x32x16_bf16 v[180:195], v[68:71], v[76:79], v[180:195]
    s_nop 15
L_sk0:
    s_add_u32 s15, s15, 1
    s_min_u32 s22, s14, 8
    s_cmp_le_u32 s15, s22
    s_cbranch_scc1 L_sl0
    s_cmp_lg_u32 s21, 0
    s_cbranch_scc1 L_sd0
    v_mov_b32 v12, v11
    s_nop 1
    v_permlane32_swap_b32 v11, v12
    s_nop 1
    v_max_f32 v11, v11, v12

    v_sub_f32 v48, 0, v11
    v_sub_f32 v49, 0, v11
    v_sub_f32 v50, 0, v11
    v_sub_f32 v51, 0, v11
    v_sub_f32 v52, 0, v11
    v_sub_f32 v53, 0, v11
    v_sub_f32 v54, 0, v11
    v_sub_f32 v55, 0, v11
    v_sub_f32 v56, 0, v11
    v_sub_f32 v57, 0, v11
    v_sub_f32 v58, 0, v11
    v_sub_f32 v59, 0, v11
    v_sub_f32 v60, 0, v11
    v_sub_f32 v61, 0, v11
    v_sub_f32 v62, 0, v11
    v_sub_f32 v63, 0, v11
    s_mov_b32 s21, 1
    s_branch L_sp0
L_sd0:
    v_rcp_f32 v190, v188
    s_nop 1
    s_branch L_back0

L_slow1:
    v_and_b32 v8, 31, v0
    v_lshrrev_b32 v9, 5, v0
    v_lshlrev_b32 v9, 2, v9
    v_sub_u32 v8, v8, v9
    v_mov_b32 v10, 0xf149f2ca
    v_mov_b32 v11, 0xf149f2ca
    s_add_u32 s14, s18, 1
    s_movk_i32 s20, 256

    v_mov_b32 v196, 0
    v_mov_b32 v48, 0
    v_mov_b32 v197, 0
    v_mov_b32 v49, 0
    v_mov_b32 v198, 0
    v_mov_b32 v50, 0
    v_mov_b32 v199, 0
    v_mov_b32 v51, 0
    v_mov_b32 v200, 0
    v_mov_b32 v52, 0
    v_mov_b32 v201, 0
    v_mov_b32 v53, 0
    v_mov_b32 v202, 0
    v_mov_b32 v54, 0
    v_mov_b32 v203, 0
    v_mov_b32 v55, 0
    v_mov_b32 v204, 0
    v_mov_b32 v56, 0
    v_mov_b32 v205, 0
    v_mov_b32 v57, 0
    v_mov_b32 v206, 0
    v_mov_b32 v58, 0
    v_mov_b32 v207, 0
    v_mov_b32 v59, 0
    v_mov_b32 v208, 0
    v_mov_b32 v60, 0
    v_mov_b32 v209, 0
    v_mov_b32 v61, 0
    v_mov_b32 v210, 0
    v_mov_b32 v62, 0
    v_mov_b32 v211, 0
    v_mov_b32 v63, 0
    v_mov_b32 v64, 0x3f803f80
    v_mov_b32 v65, 0x3f803f80
    v_mov_b32 v66, 0x3f803f80
    v_mov_b32 v67, 0x3f803f80
    v_mov_b32 v68, 0x3f803f80
    v_mov_b32 v69, 0x3f803f80
    v_mov_b32 v70, 0x3f803f80
    v_mov_b32 v71, 0x3f803f80
    s_mov_b32 s21, 0
L_sp1:
    s_mov_b32 s15, 0
L_sl1:
    s_sub_u32 s22, s14, s15
    s_lshl_b32 s22, s22, 13
    s_add_u32 s22, s22, s19
    buffer_load_dwordx4 v[152:155], v1, s[40:43], s22 offen sc1
    s_mov_b64 exec, s[10:11]
    buffer_load_dwordx4 v[64:67], v1, s[40:43], s22 offen offset:1024 sc1
    buffer_load_dwordx4 v[68:71], v1, s[40:43], s22 offen offset:1280 sc1
    s_mov_b64 exec, -1
    s_lshl_b32 s22, s15, 5
    v_add_u32 v9, s22, v8
    s_waitcnt vmcnt(0)
    v_mfma_f32_32x32x16_bf16 v[16:31], v[152:155], v[176:179], v[48:63]

    v_subrev_u32 v12, 0, v9
    v_cmp_gt_u32 vcc, s20, v12
    s_nop 9
    v_cndmask_b32 v16, v10, v16, vcc
    v_max_f32 v11, v11, v16
    v_exp_f32 v16, v16

    v_subrev_u32 v12, 1, v9
    v_cmp_gt_u32 vcc, s20, v12
    s_nop 1
    v_cndmask_b32 v17, v10, v17, vcc
    v_max_f32 v11, v11, v17
    v_exp_f32 v17, v17

    v_subrev_u32 v12, 2, v9
    v_cmp_gt_u32 vcc, s20, v12
    s_nop 1
    v_cndmask_b32 v18, v10, v18, vcc
    v_max_f32 v11, v11, v18
    v_exp_f32 v18, v18

    v_subrev_u32 v12, 3, v9
    v_cmp_gt_u32 vcc, s20, v12
    s_nop 1
    v_cndmask_b32 v19, v10, v19, vcc
    v_max_f32 v11, v11, v19
    v_exp_f32 v19, v19

    v_subrev_u32 v12, 8, v9
    v_cmp_gt_u32 vcc, s20, v12
    s_nop 1
    v_cndmask_b32 v20, v10, v20, vcc
    v_max_f32 v11, v11, v20
    v_exp_f32 v20, v20

    v_subrev_u32 v12, 9, v9
    v_cmp_gt_u32 vcc, s20, v12
    s_nop 1
    v_cndmask_b32 v21, v10, v21, vcc
    v_max_f32 v11, v11, v21
    v_exp_f32 v21, v21

    v_subrev_u32 v12, 10, v9
    v_cmp_gt_u32 vcc, s20, v12
    s_nop 1
    v_cndmask_b32 v22, v10, v22, vcc
    v_max_f32 v11, v11, v22
    v_exp_f32 v22, v22

    v_subrev_u32 v12, 11, v9
    v_cmp_gt_u32 vcc, s20, v12
    s_nop 1
    v_cndmask_b32 v23, v10, v23, vcc
    v_max_f32 v11, v11, v23
    v_exp_f32 v23, v23

    v_subrev_u32 v12, 16, v9
    v_cmp_gt_u32 vcc, s20, v12
    s_nop 1
    v_cndmask_b32 v24, v10, v24, vcc
    v_max_f32 v11, v11, v24
    v_exp_f32 v24, v24

    v_subrev_u32 v12, 17, v9
    v_cmp_gt_u32 vcc, s20, v12
    s_nop 1
    v_cndmask_b32 v25, v10, v25, vcc
    v_max_f32 v11, v11, v25
    v_exp_f32 v25, v25

    v_subrev_u32 v12, 18, v9
    v_cmp_gt_u32 vcc, s20, v12
    s_nop 1
    v_cndmask_b32 v26, v10, v26, vcc
    v_max_f32 v11, v11, v26
    v_exp_f32 v26, v26

    v_subrev_u32 v12, 19, v9
    v_cmp_gt_u32 vcc, s20, v12
    s_nop 1
    v_cndmask_b32 v27, v10, v27, vcc
    v_max_f32 v11, v11, v27
    v_exp_f32 v27, v27

    v_subrev_u32 v12, 24, v9
    v_cmp_gt_u32 vcc, s20, v12
    s_nop 1
    v_cndmask_b32 v28, v10, v28, vcc
    v_max_f32 v11, v11, v28
    v_exp_f32 v28, v28

    v_subrev_u32 v12, 25, v9
    v_cmp_gt_u32 vcc, s20, v12
    s_nop 1
    v_cndmask_b32 v29, v10, v29, vcc
    v_max_f32 v11, v11, v29
    v_exp_f32 v29, v29

    v_subrev_u32 v12, 26, v9
    v_cmp_gt_u32 vcc, s20, v12
    s_nop 1
    v_cndmask_b32 v30, v10, v30, vcc
    v_max_f32 v11, v11, v30
    v_exp_f32 v30, v30

    v_subrev_u32 v12, 27, v9
    v_cmp_gt_u32 vcc, s20, v12
    s_nop 1
    v_cndmask_b32 v31, v10, v31, vcc
    v_max_f32 v11, v11, v31
    v_exp_f32 v31, v31

    v_cvt_pk_bf16_f32 v72, v16, v17
    v_cvt_pk_bf16_f32 v73, v18, v19
    v_cvt_pk_bf16_f32 v74, v20, v21
    v_cvt_pk_bf16_f32 v75, v22, v23
    v_cvt_pk_bf16_f32 v76, v24, v25
    v_cvt_pk_bf16_f32 v77, v26, v27
    v_cvt_pk_bf16_f32 v78, v28, v29
    v_cvt_pk_bf16_f32 v79, v30, v31
    s_cmp_eq_u32 s21, 0
    s_cbranch_scc1 L_sk1
    v_mfma_f32_32x32x16_bf16 v[196:211], v[64:67], v[72:75], v[196:211]
    v_mfma_f32_32x32x16_bf16 v[196:211], v[68:71], v[76:79], v[196:211]
    s_nop 15
L_sk1:
    s_add_u32 s15, s15, 1
    s_min_u32 s22, s14, 8
    s_cmp_le_u32 s15, s22
    s_cbranch_scc1 L_sl1
    s_cmp_lg_u32 s21, 0
    s_cbranch_scc1 L_sd1
    v_mov_b32 v12, v11
    s_nop 1
    v_permlane32_swap_b32 v11, v12
    s_nop 1
    v_max_f32 v11, v11, v12

    v_sub_f32 v48, 0, v11
    v_sub_f32 v49, 0, v11
    v_sub_f32 v50, 0, v11
    v_sub_f32 v51, 0, v11
    v_sub_f32 v52, 0, v11
    v_sub_f32 v53, 0, v11
    v_sub_f32 v54, 0, v11
    v_sub_f32 v55, 0, v11
    v_sub_f32 v56, 0, v11
    v_sub_f32 v57, 0, v11
    v_sub_f32 v58, 0, v11
    v_sub_f32 v59, 0, v11
    v_sub_f32 v60, 0, v11
    v_sub_f32 v61, 0, v11
    v_sub_f32 v62, 0, v11
    v_sub_f32 v63, 0, v11
    s_mov_b32 s21, 1
    s_branch L_sp1
L_sd1:
    v_rcp_f32 v206, v204
    s_nop 1
    s_branch L_back1

    .p2alignl 12, 0xBF810000
    .fill 64, 4, 0xBF810000
.section .rodata,"a"
.p2align 6
.amdhsa_kernel sequential_preLN__sliding_block__moe_arch_mod__prompt_kernel
  .amdhsa_next_free_vgpr 256
  .amdhsa_next_free_sgpr 102
  .amdhsa_accum_offset 256
  .amdhsa_group_segment_fixed_size 0
  .amdhsa_kernarg_size 88
  .amdhsa_user_sgpr_count 2
  .amdhsa_user_sgpr_kernarg_segment_ptr 1
  .amdhsa_system_sgpr_workgroup_id_x 1
.end_amdhsa_kernel
```
